```python
import torch

def _softmax(x, axis=-1):
    return torch.softmax(x, dim=axis)

def _gelu(x):
    return torch.nn.functional.gelu(x, approximate='tanh')

def _silu(x):
    return torch.nn.functional.silu(x)

def _sigmoid(x):
    return torch.sigmoid(x)

def _layernorm(x, axis=-1, eps=1e-05):
    m = x.mean(dim=axis, keepdim=True)
    v = x.var(dim=axis, keepdim=True, unbiased=False)
    return (x - m) / torch.sqrt(v + eps)

def _scatter_add(tgt, idx, src, axis=0):
    return tgt.clone().index_add_(axis, idx, src)

def _segment_sum(src, seg, n):
    out = torch.zeros((n,) + src.shape[1:], dtype=src.dtype)
    return out.index_add_(0, seg, src)

def _pad(x, pw):
    flat = tuple((v for pair in reversed(pw) for v in pair))
    return torch.nn.functional.pad(x, flat)
kernel_name = 'standalone__tensor_product_equiv_equiformer__graph'

def setup_inputs():

    _w = lambda a: (lambda t: t.to(torch.bfloat16) if t.is_floating_point() else t)(torch.as_tensor(a))
    N, deg, C, De = (10000, 64, 64, max(16, 1))
    E = N * deg
    src = (lambda lo, hi, *s: torch.randint(lo, hi, s))(0, N, E).to(torch.int64)
    dst = (lambda lo, hi, *s: torch.randint(lo, hi, s))(0, N, E).to(torch.int64)
    rvec = (lambda *s: torch.randn(*s, dtype=torch.bfloat16) * 0.05)(E, 3).to(float)
    rn = (torch.linalg.norm(rvec, dim=-1, keepdim=True) + 1e-06).to(float)
    rhat = (rvec / rn).to(float)
    eps = torch.zeros((3, 3, 3), dtype=float)
    eps[0, 1, 2] = eps[1, 2, 0] = eps[2, 0, 1] = 1.0
    eps[0, 2, 1] = eps[2, 1, 0] = eps[1, 0, 2] = -1.0
    return {'x': _w((lambda *s: torch.randn(*s, dtype=torch.bfloat16) * 0.2)(N, 4 * C).to(float)), 'rhat': _w(rhat), 'e_attr': _w((lambda *s: torch.randn(*s, dtype=torch.bfloat16) * 0.2)(E, De).to(float)), 'src': _w(src), 'dst': _w(dst), 'w_rad': _w((lambda *s: torch.randn(*s, dtype=torch.bfloat16) * 0.2)(De, 5 * C).to(float)), 'w_si0': _w((lambda *s: torch.randn(*s, dtype=torch.bfloat16) * 0.2)(2 * C, C).to(float)), 'w_si1': _w((lambda *s: torch.randn(*s, dtype=torch.bfloat16) * 0.05)(3 * C, C).to(float)), 'cg_eps': _w(eps)}

def reference(x, rhat, e_attr, src, dst, w_rad, w_si0, w_si1, cg_eps):
    N = x.shape[0]
    C = w_si0.shape[1]
    E = rhat.shape[0]
    x0 = x[:, :C].clone()
    x1 = x[:, C:].reshape(N, 3, C)
    R = (e_attr @ w_rad).reshape(E, 5, C)
    f0 = x0[src]
    f1 = x1[src]
    Y1 = rhat
    p00_0 = f0 * R[:, 0, :]
    p11_0 = torch.einsum('ejc,ej->ec', f1, Y1) * R[:, 1, :]
    p01_1 = torch.einsum('ec,ej->ejc', f0, Y1) * R[:, 2, :][:, None, :]
    p10_1 = f1 * R[:, 3, :][:, None, :]
    p11_1 = torch.einsum('ijk,ekc,ej->eic', cg_eps, f1, Y1) * R[:, 4, :][:, None, :]
    m0 = torch.concatenate([p00_0, p11_0], axis=-1) @ w_si0
    m1 = torch.einsum('ejp,pc->ejc', torch.concatenate([p01_1, p10_1, p11_1], axis=-1), w_si1)
    agg0 = _segment_sum(m0, dst, N)
    agg1 = _segment_sum(m1.reshape(E, 3 * C), dst, N).reshape(N, 3, C)
    gate = _sigmoid(agg0)
    out1 = agg1 * gate[:, None, :]
    return torch.concatenate([agg0, out1.reshape(N, 3 * C)], axis=-1)
```

```asm
; @launch kernel=hist_kernel grid=(64,1,1) block=(1024,1,1) lds=40000
; @launch kernel=scan_kernel grid=(217,1,1) block=(64,1,1) lds=0
; @launch kernel=scatter_kernel grid=(64,1,1) block=(1024,1,1) lds=40448
; @launch kernel=main_kernel grid=(625,1,1) block=(256,1,1) lds=39168
.amdgcn_target "amdgcn-amd-amdhsa--gfx950"
.text
.p2align 8
.globl hist_kernel
.type hist_kernel,@function
hist_kernel:
    s_cmp_ge_u32 s2, 64
    s_cbranch_scc1 L_hist_end
    s_load_dwordx2 s[4:5], s[0:1], 32
    s_load_dwordx2 s[6:7], s[0:1], 88
    v_lshlrev_b32 v1, 2, v0
    v_mov_b32 v2, 0
    ds_write_b32 v1, v2 offset:0
    ds_write_b32 v1, v2 offset:4096
    ds_write_b32 v1, v2 offset:8192
    ds_write_b32 v1, v2 offset:12288
    ds_write_b32 v1, v2 offset:16384
    ds_write_b32 v1, v2 offset:20480
    ds_write_b32 v1, v2 offset:24576
    ds_write_b32 v1, v2 offset:28672
    ds_write_b32 v1, v2 offset:32768
    v_cmp_gt_u32 vcc, 784, v0
    s_and_saveexec_b64 s[20:21], vcc
    ds_write_b32 v1, v2 offset:36864
    s_mov_b64 exec, s[20:21]
    s_waitcnt lgkmcnt(0)
    s_mov_b32 s8, s4
    s_and_b32 s9, s5, 0xffff
    s_mov_b32 s10, 2560000
    s_mov_b32 s11, 0x00020000
    s_mov_b32 s12, s6
    s_and_b32 s13, s7, 0xffff
    s_mov_b32 s14, 268435456
    s_mov_b32 s15, 0x00020000
    s_barrier
    s_mul_i32 s3, s2, 40000
    v_add_u32 v3, s3, v1
    s_mov_b32 s16, 0
    buffer_load_dword v10, v3, s[8:11], s16 offen
    s_mov_b32 s16, 4096
    buffer_load_dword v11, v3, s[8:11], s16 offen
    s_mov_b32 s16, 8192
    buffer_load_dword v12, v3, s[8:11], s16 offen
    s_mov_b32 s16, 12288
    buffer_load_dword v13, v3, s[8:11], s16 offen
    s_mov_b32 s16, 16384
    buffer_load_dword v14, v3, s[8:11], s16 offen
    s_mov_b32 s16, 20480
    buffer_load_dword v15, v3, s[8:11], s16 offen
    s_mov_b32 s16, 24576
    buffer_load_dword v16, v3, s[8:11], s16 offen
    s_mov_b32 s16, 28672
    buffer_load_dword v17, v3, s[8:11], s16 offen
    s_mov_b32 s16, 32768
    buffer_load_dword v18, v3, s[8:11], s16 offen
    s_mov_b32 s16, 36864
    buffer_load_dword v19, v3, s[8:11], s16 offen
    v_mov_b32 v4, 1
    s_waitcnt vmcnt(0)
    v_lshlrev_b32 v5, 2, v10
    ds_add_u32 v5, v4
    v_lshlrev_b32 v5, 2, v11
    ds_add_u32 v5, v4
    v_lshlrev_b32 v5, 2, v12
    ds_add_u32 v5, v4
    v_lshlrev_b32 v5, 2, v13
    ds_add_u32 v5, v4
    v_lshlrev_b32 v5, 2, v14
    ds_add_u32 v5, v4
    v_lshlrev_b32 v5, 2, v15
    ds_add_u32 v5, v4
    v_lshlrev_b32 v5, 2, v16
    ds_add_u32 v5, v4
    v_lshlrev_b32 v5, 2, v17
    ds_add_u32 v5, v4
    v_lshlrev_b32 v5, 2, v18
    ds_add_u32 v5, v4
    v_cmp_gt_u32 vcc, 784, v0
    s_and_saveexec_b64 s[20:21], vcc
    v_lshlrev_b32 v5, 2, v19
    ds_add_u32 v5, v4
    s_mov_b64 exec, s[20:21]
    s_waitcnt lgkmcnt(0)
    s_barrier
    ds_read_b32 v10, v1 offset:0
    ds_read_b32 v11, v1 offset:4096
    ds_read_b32 v12, v1 offset:8192
    ds_read_b32 v13, v1 offset:12288
    ds_read_b32 v14, v1 offset:16384
    ds_read_b32 v15, v1 offset:20480
    ds_read_b32 v16, v1 offset:24576
    ds_read_b32 v17, v1 offset:28672
    ds_read_b32 v18, v1 offset:32768
    v_cmp_gt_u32 vcc, 784, v0
    s_and_saveexec_b64 s[20:21], vcc
    ds_read_b32 v19, v1 offset:36864
    s_mov_b64 exec, s[20:21]
    s_waitcnt lgkmcnt(0)
    s_mul_i32 s3, s2, 40000
    s_add_u32 s3, s3, 0
    v_add_u32 v3, s3, v1
    s_mov_b32 s16, 0
    buffer_store_dword v10, v3, s[12:15], s16 offen
    s_mov_b32 s16, 4096
    buffer_store_dword v11, v3, s[12:15], s16 offen
    s_mov_b32 s16, 8192
    buffer_store_dword v12, v3, s[12:15], s16 offen
    s_mov_b32 s16, 12288
    buffer_store_dword v13, v3, s[12:15], s16 offen
    s_mov_b32 s16, 16384
    buffer_store_dword v14, v3, s[12:15], s16 offen
    s_mov_b32 s16, 20480
    buffer_store_dword v15, v3, s[12:15], s16 offen
    s_mov_b32 s16, 24576
    buffer_store_dword v16, v3, s[12:15], s16 offen
    s_mov_b32 s16, 28672
    buffer_store_dword v17, v3, s[12:15], s16 offen
    s_mov_b32 s16, 32768
    buffer_store_dword v18, v3, s[12:15], s16 offen
    v_cmp_gt_u32 vcc, 784, v0
    s_and_saveexec_b64 s[20:21], vcc
    s_mov_b32 s16, 36864
    buffer_store_dword v19, v3, s[12:15], s16 offen
L_hist_end:
    s_endpgm
.p2align 8
.globl scan_kernel
.type scan_kernel,@function
scan_kernel:
    s_cmp_ge_u32 s2, 217
    s_cbranch_scc1 L_scan_end
    s_load_dwordx2 s[6:7], s[0:1], 88
    s_load_dwordx2 s[24:25], s[0:1], 40
    s_load_dwordx2 s[26:27], s[0:1], 48
    s_load_dwordx2 s[28:29], s[0:1], 56
    s_waitcnt lgkmcnt(0)
    s_mov_b32 s12, s6
    s_and_b32 s13, s7, 0xffff
    s_mov_b32 s14, 268435456
    s_mov_b32 s15, 0x00020000
    s_cmp_ge_u32 s2, 157
    s_cbranch_scc1 L_prep
    s_lshl_b32 s3, s2, 6
    v_add_u32 v1, s3, v0
    v_cmp_gt_u32 vcc, 10000, v1
    s_and_saveexec_b64 s[20:21], vcc
    s_cbranch_execz L_scan_end
    v_lshlrev_b32 v1, 2, v1
    s_mov_b32 s16, 0
    buffer_load_dword v10, v1, s[12:15], s16 offen
    s_mov_b32 s16, 40000
    buffer_load_dword v11, v1, s[12:15], s16 offen
    s_mov_b32 s16, 80000
    buffer_load_dword v12, v1, s[12:15], s16 offen
    s_mov_b32 s16, 120000
    buffer_load_dword v13, v1, s[12:15], s16 offen
    s_mov_b32 s16, 160000
    buffer_load_dword v14, v1, s[12:15], s16 offen
    s_mov_b32 s16, 200000
    buffer_load_dword v15, v1, s[12:15], s16 offen
    s_mov_b32 s16, 240000
    buffer_load_dword v16, v1, s[12:15], s16 offen
    s_mov_b32 s16, 280000
    buffer_load_dword v17, v1, s[12:15], s16 offen
    s_mov_b32 s16, 320000
    buffer_load_dword v18, v1, s[12:15], s16 offen
    s_mov_b32 s16, 360000
    buffer_load_dword v19, v1, s[12:15], s16 offen
    s_mov_b32 s16, 400000
    buffer_load_dword v20, v1, s[12:15], s16 offen
    s_mov_b32 s16, 440000
    buffer_load_dword v21, v1, s[12:15], s16 offen
    s_mov_b32 s16, 480000
    buffer_load_dword v22, v1, s[12:15], s16 offen
    s_mov_b32 s16, 520000
    buffer_load_dword v23, v1, s[12:15], s16 offen
    s_mov_b32 s16, 560000
    buffer_load_dword v24, v1, s[12:15], s16 offen
    s_mov_b32 s16, 600000
    buffer_load_dword v25, v1, s[12:15], s16 offen
    s_mov_b32 s16, 640000
    buffer_load_dword v26, v1, s[12:15], s16 offen
    s_mov_b32 s16, 680000
    buffer_load_dword v27, v1, s[12:15], s16 offen
    s_mov_b32 s16, 720000
    buffer_load_dword v28, v1, s[12:15], s16 offen
    s_mov_b32 s16, 760000
    buffer_load_dword v29, v1, s[12:15], s16 offen
    s_mov_b32 s16, 800000
    buffer_load_dword v30, v1, s[12:15], s16 offen
    s_mov_b32 s16, 840000
    buffer_load_dword v31, v1, s[12:15], s16 offen
    s_mov_b32 s16, 880000
    buffer_load_dword v32, v1, s[12:15], s16 offen
    s_mov_b32 s16, 920000
    buffer_load_dword v33, v1, s[12:15], s16 offen
    s_mov_b32 s16, 960000
    buffer_load_dword v34, v1, s[12:15], s16 offen
    s_mov_b32 s16, 1000000
    buffer_load_dword v35, v1, s[12:15], s16 offen
    s_mov_b32 s16, 1040000
    buffer_load_dword v36, v1, s[12:15], s16 offen
    s_mov_b32 s16, 1080000
    buffer_load_dword v37, v1, s[12:15], s16 offen
    s_mov_b32 s16, 1120000
    buffer_load_dword v38, v1, s[12:15], s16 offen
    s_mov_b32 s16, 1160000
    buffer_load_dword v39, v1, s[12:15], s16 offen
    s_mov_b32 s16, 1200000
    buffer_load_dword v40, v1, s[12:15], s16 offen
    s_mov_b32 s16, 1240000
    buffer_load_dword v41, v1, s[12:15], s16 offen
    s_mov_b32 s16, 1280000
    buffer_load_dword v42, v1, s[12:15], s16 offen
    s_mov_b32 s16, 1320000
    buffer_load_dword v43, v1, s[12:15], s16 offen
    s_mov_b32 s16, 1360000
    buffer_load_dword v44, v1, s[12:15], s16 offen
    s_mov_b32 s16, 1400000
    buffer_load_dword v45, v1, s[12:15], s16 offen
    s_mov_b32 s16, 1440000
    buffer_load_dword v46, v1, s[12:15], s16 offen
    s_mov_b32 s16, 1480000
    buffer_load_dword v47, v1, s[12:15], s16 offen
    s_mov_b32 s16, 1520000
    buffer_load_dword v48, v1, s[12:15], s16 offen
    s_mov_b32 s16, 1560000
    buffer_load_dword v49, v1, s[12:15], s16 offen
    s_mov_b32 s16, 1600000
    buffer_load_dword v50, v1, s[12:15], s16 offen
    s_mov_b32 s16, 1640000
    buffer_load_dword v51, v1, s[12:15], s16 offen
    s_mov_b32 s16, 1680000
    buffer_load_dword v52, v1, s[12:15], s16 offen
    s_mov_b32 s16, 1720000
    buffer_load_dword v53, v1, s[12:15], s16 offen
    s_mov_b32 s16, 1760000
    buffer_load_dword v54, v1, s[12:15], s16 offen
    s_mov_b32 s16, 1800000
    buffer_load_dword v55, v1, s[12:15], s16 offen
    s_mov_b32 s16, 1840000
    buffer_load_dword v56, v1, s[12:15], s16 offen
    s_mov_b32 s16, 1880000
    buffer_load_dword v57, v1, s[12:15], s16 offen
    s_mov_b32 s16, 1920000
    buffer_load_dword v58, v1, s[12:15], s16 offen
    s_mov_b32 s16, 1960000
    buffer_load_dword v59, v1, s[12:15], s16 offen
    s_mov_b32 s16, 2000000
    buffer_load_dword v60, v1, s[12:15], s16 offen
    s_mov_b32 s16, 2040000
    buffer_load_dword v61, v1, s[12:15], s16 offen
    s_mov_b32 s16, 2080000
    buffer_load_dword v62, v1, s[12:15], s16 offen
    s_mov_b32 s16, 2120000
    buffer_load_dword v63, v1, s[12:15], s16 offen
    s_mov_b32 s16, 2160000
    buffer_load_dword v64, v1, s[12:15], s16 offen
    s_mov_b32 s16, 2200000
    buffer_load_dword v65, v1, s[12:15], s16 offen
    s_mov_b32 s16, 2240000
    buffer_load_dword v66, v1, s[12:15], s16 offen
    s_mov_b32 s16, 2280000
    buffer_load_dword v67, v1, s[12:15], s16 offen
    s_mov_b32 s16, 2320000
    buffer_load_dword v68, v1, s[12:15], s16 offen
    s_mov_b32 s16, 2360000
    buffer_load_dword v69, v1, s[12:15], s16 offen
    s_mov_b32 s16, 2400000
    buffer_load_dword v70, v1, s[12:15], s16 offen
    s_mov_b32 s16, 2440000
    buffer_load_dword v71, v1, s[12:15], s16 offen
    s_mov_b32 s16, 2480000
    buffer_load_dword v72, v1, s[12:15], s16 offen
    s_mov_b32 s16, 2520000
    buffer_load_dword v73, v1, s[12:15], s16 offen
    v_mov_b32 v2, 0
    s_waitcnt vmcnt(0)
    s_mov_b32 s16, 0
    buffer_store_dword v2, v1, s[12:15], s16 offen
    v_add_u32 v2, v2, v10
    s_mov_b32 s16, 40000
    buffer_store_dword v2, v1, s[12:15], s16 offen
    v_add_u32 v2, v2, v11
    s_mov_b32 s16, 80000
    buffer_store_dword v2, v1, s[12:15], s16 offen
    v_add_u32 v2, v2, v12
    s_mov_b32 s16, 120000
    buffer_store_dword v2, v1, s[12:15], s16 offen
    v_add_u32 v2, v2, v13
    s_mov_b32 s16, 160000
    buffer_store_dword v2, v1, s[12:15], s16 offen
    v_add_u32 v2, v2, v14
    s_mov_b32 s16, 200000
    buffer_store_dword v2, v1, s[12:15], s16 offen
    v_add_u32 v2, v2, v15
    s_mov_b32 s16, 240000
    buffer_store_dword v2, v1, s[12:15], s16 offen
    v_add_u32 v2, v2, v16
    s_mov_b32 s16, 280000
    buffer_store_dword v2, v1, s[12:15], s16 offen
    v_add_u32 v2, v2, v17
    s_mov_b32 s16, 320000
    buffer_store_dword v2, v1, s[12:15], s16 offen
    v_add_u32 v2, v2, v18
    s_mov_b32 s16, 360000
    buffer_store_dword v2, v1, s[12:15], s16 offen
    v_add_u32 v2, v2, v19
    s_mov_b32 s16, 400000
    buffer_store_dword v2, v1, s[12:15], s16 offen
    v_add_u32 v2, v2, v20
    s_mov_b32 s16, 440000
    buffer_store_dword v2, v1, s[12:15], s16 offen
    v_add_u32 v2, v2, v21
    s_mov_b32 s16, 480000
    buffer_store_dword v2, v1, s[12:15], s16 offen
    v_add_u32 v2, v2, v22
    s_mov_b32 s16, 520000
    buffer_store_dword v2, v1, s[12:15], s16 offen
    v_add_u32 v2, v2, v23
    s_mov_b32 s16, 560000
    buffer_store_dword v2, v1, s[12:15], s16 offen
    v_add_u32 v2, v2, v24
    s_mov_b32 s16, 600000
    buffer_store_dword v2, v1, s[12:15], s16 offen
    v_add_u32 v2, v2, v25
    s_mov_b32 s16, 640000
    buffer_store_dword v2, v1, s[12:15], s16 offen
    v_add_u32 v2, v2, v26
    s_mov_b32 s16, 680000
    buffer_store_dword v2, v1, s[12:15], s16 offen
    v_add_u32 v2, v2, v27
    s_mov_b32 s16, 720000
    buffer_store_dword v2, v1, s[12:15], s16 offen
    v_add_u32 v2, v2, v28
    s_mov_b32 s16, 760000
    buffer_store_dword v2, v1, s[12:15], s16 offen
    v_add_u32 v2, v2, v29
    s_mov_b32 s16, 800000
    buffer_store_dword v2, v1, s[12:15], s16 offen
    v_add_u32 v2, v2, v30
    s_mov_b32 s16, 840000
    buffer_store_dword v2, v1, s[12:15], s16 offen
    v_add_u32 v2, v2, v31
    s_mov_b32 s16, 880000
    buffer_store_dword v2, v1, s[12:15], s16 offen
    v_add_u32 v2, v2, v32
    s_mov_b32 s16, 920000
    buffer_store_dword v2, v1, s[12:15], s16 offen
    v_add_u32 v2, v2, v33
    s_mov_b32 s16, 960000
    buffer_store_dword v2, v1, s[12:15], s16 offen
    v_add_u32 v2, v2, v34
    s_mov_b32 s16, 1000000
    buffer_store_dword v2, v1, s[12:15], s16 offen
    v_add_u32 v2, v2, v35
    s_mov_b32 s16, 1040000
    buffer_store_dword v2, v1, s[12:15], s16 offen
    v_add_u32 v2, v2, v36
    s_mov_b32 s16, 1080000
    buffer_store_dword v2, v1, s[12:15], s16 offen
    v_add_u32 v2, v2, v37
    s_mov_b32 s16, 1120000
    buffer_store_dword v2, v1, s[12:15], s16 offen
    v_add_u32 v2, v2, v38
    s_mov_b32 s16, 1160000
    buffer_store_dword v2, v1, s[12:15], s16 offen
    v_add_u32 v2, v2, v39
    s_mov_b32 s16, 1200000
    buffer_store_dword v2, v1, s[12:15], s16 offen
    v_add_u32 v2, v2, v40
    s_mov_b32 s16, 1240000
    buffer_store_dword v2, v1, s[12:15], s16 offen
    v_add_u32 v2, v2, v41
    s_mov_b32 s16, 1280000
    buffer_store_dword v2, v1, s[12:15], s16 offen
    v_add_u32 v2, v2, v42
    s_mov_b32 s16, 1320000
    buffer_store_dword v2, v1, s[12:15], s16 offen
    v_add_u32 v2, v2, v43
    s_mov_b32 s16, 1360000
    buffer_store_dword v2, v1, s[12:15], s16 offen
    v_add_u32 v2, v2, v44
    s_mov_b32 s16, 1400000
    buffer_store_dword v2, v1, s[12:15], s16 offen
    v_add_u32 v2, v2, v45
    s_mov_b32 s16, 1440000
    buffer_store_dword v2, v1, s[12:15], s16 offen
    v_add_u32 v2, v2, v46
    s_mov_b32 s16, 1480000
    buffer_store_dword v2, v1, s[12:15], s16 offen
    v_add_u32 v2, v2, v47
    s_mov_b32 s16, 1520000
    buffer_store_dword v2, v1, s[12:15], s16 offen
    v_add_u32 v2, v2, v48
    s_mov_b32 s16, 1560000
    buffer_store_dword v2, v1, s[12:15], s16 offen
    v_add_u32 v2, v2, v49
    s_mov_b32 s16, 1600000
    buffer_store_dword v2, v1, s[12:15], s16 offen
    v_add_u32 v2, v2, v50
    s_mov_b32 s16, 1640000
    buffer_store_dword v2, v1, s[12:15], s16 offen
    v_add_u32 v2, v2, v51
    s_mov_b32 s16, 1680000
    buffer_store_dword v2, v1, s[12:15], s16 offen
    v_add_u32 v2, v2, v52
    s_mov_b32 s16, 1720000
    buffer_store_dword v2, v1, s[12:15], s16 offen
    v_add_u32 v2, v2, v53
    s_mov_b32 s16, 1760000
    buffer_store_dword v2, v1, s[12:15], s16 offen
    v_add_u32 v2, v2, v54
    s_mov_b32 s16, 1800000
    buffer_store_dword v2, v1, s[12:15], s16 offen
    v_add_u32 v2, v2, v55
    s_mov_b32 s16, 1840000
    buffer_store_dword v2, v1, s[12:15], s16 offen
    v_add_u32 v2, v2, v56
    s_mov_b32 s16, 1880000
    buffer_store_dword v2, v1, s[12:15], s16 offen
    v_add_u32 v2, v2, v57
    s_mov_b32 s16, 1920000
    buffer_store_dword v2, v1, s[12:15], s16 offen
    v_add_u32 v2, v2, v58
    s_mov_b32 s16, 1960000
    buffer_store_dword v2, v1, s[12:15], s16 offen
    v_add_u32 v2, v2, v59
    s_mov_b32 s16, 2000000
    buffer_store_dword v2, v1, s[12:15], s16 offen
    v_add_u32 v2, v2, v60
    s_mov_b32 s16, 2040000
    buffer_store_dword v2, v1, s[12:15], s16 offen
    v_add_u32 v2, v2, v61
    s_mov_b32 s16, 2080000
    buffer_store_dword v2, v1, s[12:15], s16 offen
    v_add_u32 v2, v2, v62
    s_mov_b32 s16, 2120000
    buffer_store_dword v2, v1, s[12:15], s16 offen
    v_add_u32 v2, v2, v63
    s_mov_b32 s16, 2160000
    buffer_store_dword v2, v1, s[12:15], s16 offen
    v_add_u32 v2, v2, v64
    s_mov_b32 s16, 2200000
    buffer_store_dword v2, v1, s[12:15], s16 offen
    v_add_u32 v2, v2, v65
    s_mov_b32 s16, 2240000
    buffer_store_dword v2, v1, s[12:15], s16 offen
    v_add_u32 v2, v2, v66
    s_mov_b32 s16, 2280000
    buffer_store_dword v2, v1, s[12:15], s16 offen
    v_add_u32 v2, v2, v67
    s_mov_b32 s16, 2320000
    buffer_store_dword v2, v1, s[12:15], s16 offen
    v_add_u32 v2, v2, v68
    s_mov_b32 s16, 2360000
    buffer_store_dword v2, v1, s[12:15], s16 offen
    v_add_u32 v2, v2, v69
    s_mov_b32 s16, 2400000
    buffer_store_dword v2, v1, s[12:15], s16 offen
    v_add_u32 v2, v2, v70
    s_mov_b32 s16, 2440000
    buffer_store_dword v2, v1, s[12:15], s16 offen
    v_add_u32 v2, v2, v71
    s_mov_b32 s16, 2480000
    buffer_store_dword v2, v1, s[12:15], s16 offen
    v_add_u32 v2, v2, v72
    s_mov_b32 s16, 2520000
    buffer_store_dword v2, v1, s[12:15], s16 offen
    v_add_u32 v2, v2, v73
    s_mov_b32 s16, 2560000
    buffer_store_dword v2, v1, s[12:15], s16 offen
    s_endpgm
L_prep:
    s_cmp_ge_u32 s2, 197
    s_cbranch_scc1 L_prep_wr
    s_sub_u32 s3, s2, 157
    s_lshl_b32 s3, s3, 6
    v_add_u32 v1, s3, v0
    v_lshrrev_b32 v2, 6, v1
    v_and_b32 v3, 63, v1
    v_cmp_gt_u32 vcc, 16, v2
    v_subrev_u32 v4, 16, v2
    v_cndmask_b32 v4, v4, v2, vcc
    v_lshrrev_b32 v5, 2, v4
    v_and_b32 v6, 3, v4
    v_mul_u32_u24 v7, 43, v4
    v_lshrrev_b32 v7, 8, v7
    v_mul_u32_u24 v8, 6, v7
    v_sub_u32 v8, v4, v8
    v_cndmask_b32 v5, v7, v5, vcc
    v_cndmask_b32 v6, v8, v6, vcc
    v_lshrrev_b32 v7, 4, v3
    v_lshlrev_b32 v7, 3, v7
    v_lshl_add_u32 v7, v6, 5, v7
    v_and_b32 v8, 15, v3
    v_lshl_add_u32 v8, v5, 4, v8
    v_lshl_add_u32 v9, v7, 6, v8
    v_lshlrev_b32 v9, 1, v9
    s_mov_b32 s32, s26
    s_and_b32 s33, s27, 0xffff
    s_mov_b32 s34, 16384
    s_mov_b32 s35, 0x00020000
    s_mov_b32 s36, s28
    s_and_b32 s37, s29, 0xffff
    s_mov_b32 s38, 24576
    s_mov_b32 s39, 0x00020000
    s_cmp_ge_u32 s2, 173
    s_cbranch_scc1 L_prep_w1
    buffer_load_ushort v20, v9, s[32:35], 0 offen offset:0
    buffer_load_ushort v21, v9, s[32:35], 0 offen offset:128
    buffer_load_ushort v22, v9, s[32:35], 0 offen offset:256
    buffer_load_ushort v23, v9, s[32:35], 0 offen offset:384
    buffer_load_ushort v24, v9, s[32:35], 0 offen offset:512
    buffer_load_ushort v25, v9, s[32:35], 0 offen offset:640
    buffer_load_ushort v26, v9, s[32:35], 0 offen offset:768
    buffer_load_ushort v27, v9, s[32:35], 0 offen offset:896
    s_branch L_prep_st
L_prep_w1:
    buffer_load_ushort v20, v9, s[36:39], 0 offen offset:0
    buffer_load_ushort v21, v9, s[36:39], 0 offen offset:128
    buffer_load_ushort v22, v9, s[36:39], 0 offen offset:256
    buffer_load_ushort v23, v9, s[36:39], 0 offen offset:384
    buffer_load_ushort v24, v9, s[36:39], 0 offen offset:512
    buffer_load_ushort v25, v9, s[36:39], 0 offen offset:640
    buffer_load_ushort v26, v9, s[36:39], 0 offen offset:768
    buffer_load_ushort v27, v9, s[36:39], 0 offen offset:896
L_prep_st:
    s_waitcnt vmcnt(0)
    v_lshl_or_b32 v30, v21, 16, v20
    v_lshl_or_b32 v31, v23, 16, v22
    v_lshl_or_b32 v32, v25, 16, v24
    v_lshl_or_b32 v33, v27, 16, v26
    v_lshlrev_b32 v9, 4, v1
    s_mov_b32 s16, 2762752
    buffer_store_dwordx4 v[30:33], v9, s[12:15], s16 offen
    s_endpgm
L_prep_wr:
    s_mov_b32 s32, s24
    s_and_b32 s33, s25, 0xffff
    s_mov_b32 s34, 10240
    s_mov_b32 s35, 0x00020000
    s_sub_u32 s3, s2, 197
    s_lshl_b32 s3, s3, 6
    v_add_u32 v1, s3, v0
    v_lshrrev_b32 v2, 6, v1
    v_and_b32 v3, 63, v1
    v_lshrrev_b32 v4, 2, v2
    v_and_b32 v5, 3, v2
    v_and_b32 v6, 15, v3
    v_lshrrev_b32 v7, 4, v3
    v_lshlrev_b32 v8, 6, v4
    v_lshl_add_u32 v8, v6, 2, v8
    v_add_u32 v8, v8, v5
    v_mul_u32_u24 v9, 1280, v7
    v_add_u32 v9, v9, v8
    v_lshlrev_b32 v9, 1, v9
    buffer_load_ushort v20, v9, s[32:35], 0 offen offset:0
    buffer_load_ushort v21, v9, s[32:35], 0 offen offset:640
    buffer_load_ushort v22, v9, s[32:35], 0 offen offset:1280
    buffer_load_ushort v23, v9, s[32:35], 0 offen offset:1920
    s_waitcnt vmcnt(0)
    v_lshl_or_b32 v30, v21, 16, v20
    v_lshl_or_b32 v31, v23, 16, v22
    v_lshlrev_b32 v9, 3, v1
    s_mov_b32 s16, 2752512
    buffer_store_dwordx2 v[30:31], v9, s[12:15], s16 offen
L_scan_end:
    s_endpgm
.p2align 8
.globl scatter_kernel
.type scatter_kernel,@function
scatter_kernel:
    s_cmp_ge_u32 s2, 64
    s_cbranch_scc1 L_sc_end
    s_load_dwordx2 s[4:5], s[0:1], 32
    s_load_dwordx2 s[6:7], s[0:1], 88
    s_load_dwordx2 s[24:25], s[0:1], 24
    s_load_dwordx2 s[26:27], s[0:1], 8
    s_waitcnt lgkmcnt(0)
    s_mov_b32 s8, s4
    s_and_b32 s9, s5, 0xffff
    s_mov_b32 s10, 2560000
    s_mov_b32 s11, 0x00020000
    s_mov_b32 s12, s6
    s_and_b32 s13, s7, 0xffff
    s_mov_b32 s14, 268435456
    s_mov_b32 s15, 0x00020000
    s_mov_b32 s28, s24
    s_and_b32 s29, s25, 0xffff
    s_mov_b32 s30, 2560000
    s_mov_b32 s31, 0x00020000
    s_mov_b32 s32, s26
    s_and_b32 s33, s27, 0xffff
    s_mov_b32 s34, 3840000
    s_mov_b32 s35, 0x00020000
    v_mul_u32_u24 v1, 40, v0
    v_mov_b32 v40, 0
    v_mov_b32 v10, 0
    v_mov_b32 v20, 0
    v_mov_b32 v11, 0
    v_mov_b32 v21, 0
    v_mov_b32 v12, 0
    v_mov_b32 v22, 0
    v_mov_b32 v13, 0
    v_mov_b32 v23, 0
    v_mov_b32 v14, 0
    v_mov_b32 v24, 0
    v_mov_b32 v15, 0
    v_mov_b32 v25, 0
    v_mov_b32 v16, 0
    v_mov_b32 v26, 0
    v_mov_b32 v17, 0
    v_mov_b32 v27, 0
    v_mov_b32 v18, 0
    v_mov_b32 v28, 0
    v_mov_b32 v19, 0
    v_mov_b32 v29, 0
    v_cmp_gt_u32 vcc, 1000, v0
    s_and_saveexec_b64 s[20:21], vcc
    s_mov_b32 s16, 2560000
    s_mul_i32 s17, s2, 40000
    s_add_u32 s17, s17, 0
    buffer_load_dword v10, v1, s[12:15], s16 offen offset:0
    buffer_load_dword v20, v1, s[12:15], s17 offen offset:0
    buffer_load_dword v11, v1, s[12:15], s16 offen offset:4
    buffer_load_dword v21, v1, s[12:15], s17 offen offset:4
    buffer_load_dword v12, v1, s[12:15], s16 offen offset:8
    buffer_load_dword v22, v1, s[12:15], s17 offen offset:8
    buffer_load_dword v13, v1, s[12:15], s16 offen offset:12
    buffer_load_dword v23, v1, s[12:15], s17 offen offset:12
    buffer_load_dword v14, v1, s[12:15], s16 offen offset:16
    buffer_load_dword v24, v1, s[12:15], s17 offen offset:16
    buffer_load_dword v15, v1, s[12:15], s16 offen offset:20
    buffer_load_dword v25, v1, s[12:15], s17 offen offset:20
    buffer_load_dword v16, v1, s[12:15], s16 offen offset:24
    buffer_load_dword v26, v1, s[12:15], s17 offen offset:24
    buffer_load_dword v17, v1, s[12:15], s16 offen offset:28
    buffer_load_dword v27, v1, s[12:15], s17 offen offset:28
    buffer_load_dword v18, v1, s[12:15], s16 offen offset:32
    buffer_load_dword v28, v1, s[12:15], s17 offen offset:32
    buffer_load_dword v19, v1, s[12:15], s16 offen offset:36
    buffer_load_dword v29, v1, s[12:15], s17 offen offset:36
    s_mov_b64 exec, s[20:21]
    s_waitcnt vmcnt(0)
    v_mov_b32 v30, v40
    v_add_u32 v40, v40, v10
    v_mov_b32 v31, v40
    v_add_u32 v40, v40, v11
    v_mov_b32 v32, v40
    v_add_u32 v40, v40, v12
    v_mov_b32 v33, v40
    v_add_u32 v40, v40, v13
    v_mov_b32 v34, v40
    v_add_u32 v40, v40, v14
    v_mov_b32 v35, v40
    v_add_u32 v40, v40, v15
    v_mov_b32 v36, v40
    v_add_u32 v40, v40, v16
    v_mov_b32 v37, v40
    v_add_u32 v40, v40, v17
    v_mov_b32 v38, v40
    v_add_u32 v40, v40, v18
    v_mov_b32 v39, v40
    v_add_u32 v40, v40, v19
    v_mov_b32 v41, v40
    v_mov_b32 v42, 0
    s_nop 1
    v_mov_b32_dpp v42, v41 row_shr:1 row_mask:0xf bank_mask:0xf
    v_add_u32 v41, v41, v42
    v_mov_b32 v42, 0
    s_nop 1
    v_mov_b32_dpp v42, v41 row_shr:2 row_mask:0xf bank_mask:0xf
    v_add_u32 v41, v41, v42
    v_mov_b32 v42, 0
    s_nop 1
    v_mov_b32_dpp v42, v41 row_shr:4 row_mask:0xf bank_mask:0xf
    v_add_u32 v41, v41, v42
    v_mov_b32 v42, 0
    s_nop 1
    v_mov_b32_dpp v42, v41 row_shr:8 row_mask:0xf bank_mask:0xf
    v_add_u32 v41, v41, v42
    v_mov_b32 v42, 0
    s_nop 1
    v_mov_b32_dpp v42, v41 row_bcast:15 row_mask:0xa bank_mask:0xf
    v_add_u32 v41, v41, v42
    v_mov_b32 v42, 0
    s_nop 1
    v_mov_b32_dpp v42, v41 row_bcast:31 row_mask:0xc bank_mask:0xf
    v_add_u32 v41, v41, v42
    v_lshrrev_b32 v43, 6, v0
    v_lshlrev_b32 v43, 2, v43
    v_and_b32 v44, 63, v0
    v_cmp_eq_u32 vcc, 63, v44
    s_and_saveexec_b64 s[20:21], vcc
    ds_write_b32 v43, v41 offset:40000
    s_mov_b64 exec, s[20:21]
    s_waitcnt lgkmcnt(0)
    s_barrier
    v_mov_b32 v45, 0
    v_mov_b32 v47, 40000
    ds_read_b32 v50, v47
    v_mov_b32 v47, 40004
    ds_read_b32 v51, v47
    v_mov_b32 v47, 40008
    ds_read_b32 v52, v47
    v_mov_b32 v47, 40012
    ds_read_b32 v53, v47
    v_mov_b32 v47, 40016
    ds_read_b32 v54, v47
    v_mov_b32 v47, 40020
    ds_read_b32 v55, v47
    v_mov_b32 v47, 40024
    ds_read_b32 v56, v47
    v_mov_b32 v47, 40028
    ds_read_b32 v57, v47
    v_mov_b32 v47, 40032
    ds_read_b32 v58, v47
    v_mov_b32 v47, 40036
    ds_read_b32 v59, v47
    v_mov_b32 v47, 40040
    ds_read_b32 v60, v47
    v_mov_b32 v47, 40044
    ds_read_b32 v61, v47
    v_mov_b32 v47, 40048
    ds_read_b32 v62, v47
    v_mov_b32 v47, 40052
    ds_read_b32 v63, v47
    v_mov_b32 v47, 40056
    ds_read_b32 v64, v47
    v_mov_b32 v47, 40060
    ds_read_b32 v65, v47
    s_waitcnt lgkmcnt(0)
    v_lshrrev_b32 v46, 6, v0
    v_cmp_lt_u32 vcc, 0, v46
    s_nop 1
    v_cndmask_b32 v47, 0, v50, vcc
    v_add_u32 v45, v45, v47
    v_cmp_lt_u32 vcc, 1, v46
    s_nop 1
    v_cndmask_b32 v47, 0, v51, vcc
    v_add_u32 v45, v45, v47
    v_cmp_lt_u32 vcc, 2, v46
    s_nop 1
    v_cndmask_b32 v47, 0, v52, vcc
    v_add_u32 v45, v45, v47
    v_cmp_lt_u32 vcc, 3, v46
    s_nop 1
    v_cndmask_b32 v47, 0, v53, vcc
    v_add_u32 v45, v45, v47
    v_cmp_lt_u32 vcc, 4, v46
    s_nop 1
    v_cndmask_b32 v47, 0, v54, vcc
    v_add_u32 v45, v45, v47
    v_cmp_lt_u32 vcc, 5, v46
    s_nop 1
    v_cndmask_b32 v47, 0, v55, vcc
    v_add_u32 v45, v45, v47
    v_cmp_lt_u32 vcc, 6, v46
    s_nop 1
    v_cndmask_b32 v47, 0, v56, vcc
    v_add_u32 v45, v45, v47
    v_cmp_lt_u32 vcc, 7, v46
    s_nop 1
    v_cndmask_b32 v47, 0, v57, vcc
    v_add_u32 v45, v45, v47
    v_cmp_lt_u32 vcc, 8, v46
    s_nop 1
    v_cndmask_b32 v47, 0, v58, vcc
    v_add_u32 v45, v45, v47
    v_cmp_lt_u32 vcc, 9, v46
    s_nop 1
    v_cndmask_b32 v47, 0, v59, vcc
    v_add_u32 v45, v45, v47
    v_cmp_lt_u32 vcc, 10, v46
    s_nop 1
    v_cndmask_b32 v47, 0, v60, vcc
    v_add_u32 v45, v45, v47
    v_cmp_lt_u32 vcc, 11, v46
    s_nop 1
    v_cndmask_b32 v47, 0, v61, vcc
    v_add_u32 v45, v45, v47
    v_cmp_lt_u32 vcc, 12, v46
    s_nop 1
    v_cndmask_b32 v47, 0, v62, vcc
    v_add_u32 v45, v45, v47
    v_cmp_lt_u32 vcc, 13, v46
    s_nop 1
    v_cndmask_b32 v47, 0, v63, vcc
    v_add_u32 v45, v45, v47
    v_cmp_lt_u32 vcc, 14, v46
    s_nop 1
    v_cndmask_b32 v47, 0, v64, vcc
    v_add_u32 v45, v45, v47
    v_cmp_lt_u32 vcc, 15, v46
    s_nop 1
    v_cndmask_b32 v47, 0, v65, vcc
    v_add_u32 v45, v45, v47
    v_add_u32 v45, v45, v41
    v_sub_u32 v45, v45, v40
    v_cmp_gt_u32 vcc, 1000, v0
    s_and_saveexec_b64 s[20:21], vcc
    v_add_u32 v30, v30, v45
    v_add_u32 v47, v30, v20
    ds_write_b32 v1, v47 offset:0
    v_add_u32 v31, v31, v45
    v_add_u32 v47, v31, v21
    ds_write_b32 v1, v47 offset:4
    v_add_u32 v32, v32, v45
    v_add_u32 v47, v32, v22
    ds_write_b32 v1, v47 offset:8
    v_add_u32 v33, v33, v45
    v_add_u32 v47, v33, v23
    ds_write_b32 v1, v47 offset:12
    v_add_u32 v34, v34, v45
    v_add_u32 v47, v34, v24
    ds_write_b32 v1, v47 offset:16
    v_add_u32 v35, v35, v45
    v_add_u32 v47, v35, v25
    ds_write_b32 v1, v47 offset:20
    v_add_u32 v36, v36, v45
    v_add_u32 v47, v36, v26
    ds_write_b32 v1, v47 offset:24
    v_add_u32 v37, v37, v45
    v_add_u32 v47, v37, v27
    ds_write_b32 v1, v47 offset:28
    v_add_u32 v38, v38, v45
    v_add_u32 v47, v38, v28
    ds_write_b32 v1, v47 offset:32
    v_add_u32 v39, v39, v45
    v_add_u32 v47, v39, v29
    ds_write_b32 v1, v47 offset:36
    s_cmp_lg_u32 s2, 0
    s_cbranch_scc1 L_sc_norp
    s_mov_b32 s16, 2621440
    buffer_store_dword v30, v1, s[12:15], s16 offen offset:0
    buffer_store_dword v31, v1, s[12:15], s16 offen offset:4
    buffer_store_dword v32, v1, s[12:15], s16 offen offset:8
    buffer_store_dword v33, v1, s[12:15], s16 offen offset:12
    buffer_store_dword v34, v1, s[12:15], s16 offen offset:16
    buffer_store_dword v35, v1, s[12:15], s16 offen offset:20
    buffer_store_dword v36, v1, s[12:15], s16 offen offset:24
    buffer_store_dword v37, v1, s[12:15], s16 offen offset:28
    buffer_store_dword v38, v1, s[12:15], s16 offen offset:32
    buffer_store_dword v39, v1, s[12:15], s16 offen offset:36
    v_mov_b32 v47, 640000
    v_mov_b32 v48, 40000
    buffer_store_dword v47, v48, s[12:15], s16 offen
L_sc_norp:
    s_mov_b64 exec, s[20:21]
    s_waitcnt lgkmcnt(0)
    s_barrier
    s_mul_i32 s3, s2, 10000
    v_add_u32 v2, s3, v0
    v_mov_b32 v4, 1
    v_add_u32 v67, 0, v2
    v_lshlrev_b32 v6, 2, v67
    buffer_load_dword v70, v6, s[8:11], 0 offen
    buffer_load_dword v66, v6, s[28:31], 0 offen
    v_mul_u32_u24 v8, 6, v67
    buffer_load_ushort v68, v8, s[32:35], 0 offen
    buffer_load_ushort v71, v8, s[32:35], 0 offen offset:2
    buffer_load_ushort v69, v8, s[32:35], 0 offen offset:4
    v_add_u32 v73, 1024, v2
    v_lshlrev_b32 v6, 2, v73
    buffer_load_dword v76, v6, s[8:11], 0 offen
    buffer_load_dword v72, v6, s[28:31], 0 offen
    v_mul_u32_u24 v8, 6, v73
    buffer_load_ushort v74, v8, s[32:35], 0 offen
    buffer_load_ushort v77, v8, s[32:35], 0 offen offset:2
    buffer_load_ushort v75, v8, s[32:35], 0 offen offset:4
    v_add_u32 v79, 2048, v2
    v_lshlrev_b32 v6, 2, v79
    buffer_load_dword v82, v6, s[8:11], 0 offen
    buffer_load_dword v78, v6, s[28:31], 0 offen
    v_mul_u32_u24 v8, 6, v79
    buffer_load_ushort v80, v8, s[32:35], 0 offen
    buffer_load_ushort v83, v8, s[32:35], 0 offen offset:2
    buffer_load_ushort v81, v8, s[32:35], 0 offen offset:4
    v_add_u32 v85, 3072, v2
    v_lshlrev_b32 v6, 2, v85
    buffer_load_dword v88, v6, s[8:11], 0 offen
    buffer_load_dword v84, v6, s[28:31], 0 offen
    v_mul_u32_u24 v8, 6, v85
    buffer_load_ushort v86, v8, s[32:35], 0 offen
    buffer_load_ushort v89, v8, s[32:35], 0 offen offset:2
    buffer_load_ushort v87, v8, s[32:35], 0 offen offset:4
    v_add_u32 v91, 4096, v2
    v_lshlrev_b32 v6, 2, v91
    buffer_load_dword v94, v6, s[8:11], 0 offen
    buffer_load_dword v90, v6, s[28:31], 0 offen
    v_mul_u32_u24 v8, 6, v91
    buffer_load_ushort v92, v8, s[32:35], 0 offen
    buffer_load_ushort v95, v8, s[32:35], 0 offen offset:2
    buffer_load_ushort v93, v8, s[32:35], 0 offen offset:4
    v_add_u32 v97, 5120, v2
    v_lshlrev_b32 v6, 2, v97
    buffer_load_dword v100, v6, s[8:11], 0 offen
    buffer_load_dword v96, v6, s[28:31], 0 offen
    v_mul_u32_u24 v8, 6, v97
    buffer_load_ushort v98, v8, s[32:35], 0 offen
    buffer_load_ushort v101, v8, s[32:35], 0 offen offset:2
    buffer_load_ushort v99, v8, s[32:35], 0 offen offset:4
    v_add_u32 v103, 6144, v2
    v_lshlrev_b32 v6, 2, v103
    buffer_load_dword v106, v6, s[8:11], 0 offen
    buffer_load_dword v102, v6, s[28:31], 0 offen
    v_mul_u32_u24 v8, 6, v103
    buffer_load_ushort v104, v8, s[32:35], 0 offen
    buffer_load_ushort v107, v8, s[32:35], 0 offen offset:2
    buffer_load_ushort v105, v8, s[32:35], 0 offen offset:4
    v_add_u32 v109, 7168, v2
    v_lshlrev_b32 v6, 2, v109
    buffer_load_dword v112, v6, s[8:11], 0 offen
    buffer_load_dword v108, v6, s[28:31], 0 offen
    v_mul_u32_u24 v8, 6, v109
    buffer_load_ushort v110, v8, s[32:35], 0 offen
    buffer_load_ushort v113, v8, s[32:35], 0 offen offset:2
    buffer_load_ushort v111, v8, s[32:35], 0 offen offset:4
    v_add_u32 v115, 8192, v2
    v_lshlrev_b32 v6, 2, v115
    buffer_load_dword v118, v6, s[8:11], 0 offen
    buffer_load_dword v114, v6, s[28:31], 0 offen
    v_mul_u32_u24 v8, 6, v115
    buffer_load_ushort v116, v8, s[32:35], 0 offen
    buffer_load_ushort v119, v8, s[32:35], 0 offen offset:2
    buffer_load_ushort v117, v8, s[32:35], 0 offen offset:4
    v_cmp_gt_u32 vcc, 784, v0
    s_and_saveexec_b64 s[20:21], vcc
    v_add_u32 v121, 9216, v2
    v_lshlrev_b32 v6, 2, v121
    buffer_load_dword v124, v6, s[8:11], 0 offen
    buffer_load_dword v120, v6, s[28:31], 0 offen
    v_mul_u32_u24 v8, 6, v121
    buffer_load_ushort v122, v8, s[32:35], 0 offen
    buffer_load_ushort v125, v8, s[32:35], 0 offen offset:2
    buffer_load_ushort v123, v8, s[32:35], 0 offen offset:4
    s_mov_b64 exec, s[20:21]
    s_waitcnt vmcnt(0)
    v_lshlrev_b32 v70, 2, v70
    ds_add_rtn_u32 v70, v70, v4
    v_lshl_or_b32 v68, v71, 16, v68
    v_lshlrev_b32 v76, 2, v76
    ds_add_rtn_u32 v76, v76, v4
    v_lshl_or_b32 v74, v77, 16, v74
    v_lshlrev_b32 v82, 2, v82
    ds_add_rtn_u32 v82, v82, v4
    v_lshl_or_b32 v80, v83, 16, v80
    v_lshlrev_b32 v88, 2, v88
    ds_add_rtn_u32 v88, v88, v4
    v_lshl_or_b32 v86, v89, 16, v86
    v_lshlrev_b32 v94, 2, v94
    ds_add_rtn_u32 v94, v94, v4
    v_lshl_or_b32 v92, v95, 16, v92
    v_lshlrev_b32 v100, 2, v100
    ds_add_rtn_u32 v100, v100, v4
    v_lshl_or_b32 v98, v101, 16, v98
    v_lshlrev_b32 v106, 2, v106
    ds_add_rtn_u32 v106, v106, v4
    v_lshl_or_b32 v104, v107, 16, v104
    v_lshlrev_b32 v112, 2, v112
    ds_add_rtn_u32 v112, v112, v4
    v_lshl_or_b32 v110, v113, 16, v110
    v_lshlrev_b32 v118, 2, v118
    ds_add_rtn_u32 v118, v118, v4
    v_lshl_or_b32 v116, v119, 16, v116
    v_cmp_gt_u32 vcc, 784, v0
    s_and_saveexec_b64 s[20:21], vcc
    v_lshlrev_b32 v124, 2, v124
    ds_add_rtn_u32 v124, v124, v4
    v_lshl_or_b32 v122, v125, 16, v122
    s_mov_b64 exec, s[20:21]
    s_waitcnt lgkmcnt(0)
    s_mov_b32 s16, 4194304
    v_lshlrev_b32 v70, 4, v70
    buffer_store_dwordx4 v[66:69], v70, s[12:15], s16 offen
    v_lshlrev_b32 v76, 4, v76
    buffer_store_dwordx4 v[72:75], v76, s[12:15], s16 offen
    v_lshlrev_b32 v82, 4, v82
    buffer_store_dwordx4 v[78:81], v82, s[12:15], s16 offen
    v_lshlrev_b32 v88, 4, v88
    buffer_store_dwordx4 v[84:87], v88, s[12:15], s16 offen
    v_lshlrev_b32 v94, 4, v94
    buffer_store_dwordx4 v[90:93], v94, s[12:15], s16 offen
    v_lshlrev_b32 v100, 4, v100
    buffer_store_dwordx4 v[96:99], v100, s[12:15], s16 offen
    v_lshlrev_b32 v106, 4, v106
    buffer_store_dwordx4 v[102:105], v106, s[12:15], s16 offen
    v_lshlrev_b32 v112, 4, v112
    buffer_store_dwordx4 v[108:111], v112, s[12:15], s16 offen
    v_lshlrev_b32 v118, 4, v118
    buffer_store_dwordx4 v[114:117], v118, s[12:15], s16 offen
    v_cmp_gt_u32 vcc, 784, v0
    s_and_saveexec_b64 s[20:21], vcc
    v_lshlrev_b32 v124, 4, v124
    buffer_store_dwordx4 v[120:123], v124, s[12:15], s16 offen
L_sc_end:
    s_endpgm
.p2align 8
.globl main_kernel
.type main_kernel,@function
main_kernel:
    s_cmp_ge_u32 s2, 625
    s_cbranch_scc1 L_m_end
    s_load_dwordx2 s[4:5], s[0:1], 0
    s_load_dwordx2 s[6:7], s[0:1], 88
    s_load_dwordx2 s[24:25], s[0:1], 16
    s_load_dwordx2 s[26:27], s[0:1], 72
    s_waitcnt lgkmcnt(0)
    s_mov_b32 s8, s4
    s_and_b32 s9, s5, 0xffff
    s_mov_b32 s10, 5120000
    s_mov_b32 s11, 0x00020000
    s_mov_b32 s12, s6
    s_and_b32 s13, s7, 0xffff
    s_mov_b32 s14, 268435456
    s_mov_b32 s15, 0x00020000
    s_mov_b32 s28, s24
    s_and_b32 s29, s25, 0xffff
    s_mov_b32 s30, 20480000
    s_mov_b32 s31, 0x00020000
    s_mov_b32 s32, s26
    s_and_b32 s33, s27, 0xffff
    s_mov_b32 s34, 5120000
    s_mov_b32 s35, 0x00020000
    v_and_b32 v1, 63, v0
    v_lshrrev_b32 v2, 6, v0
    v_and_b32 v3, 15, v1
    v_lshrrev_b32 v4, 4, v1
    s_lshl_b32 s3, s2, 4
    v_lshl_add_u32 v5, v2, 2, s3
    v_add_u32 v6, v5, v4
    v_lshrrev_b32 v7, 2, v3
    v_add_u32 v7, v5, v7
    s_mov_b32 s16, 2621440
    v_lshlrev_b32 v8, 2, v6
    v_lshlrev_b32 v9, 2, v7
    buffer_load_dword v10, v8, s[12:15], s16 offen
    buffer_load_dword v11, v8, s[12:15], s16 offen offset:4
    buffer_load_dword v12, v9, s[12:15], s16 offen
    buffer_load_dword v13, v9, s[12:15], s16 offen offset:4
    s_mov_b32 s16, 2752512
    v_lshlrev_b32 v8, 3, v1
    s_mov_b32 s16, 2752512
    buffer_load_dwordx2 v[100:101], v8, s[12:15], s16 offen offset:0
    buffer_load_dwordx2 v[102:103], v8, s[12:15], s16 offen offset:512
    buffer_load_dwordx2 v[104:105], v8, s[12:15], s16 offen offset:1024
    buffer_load_dwordx2 v[106:107], v8, s[12:15], s16 offen offset:1536
    buffer_load_dwordx2 v[108:109], v8, s[12:15], s16 offen offset:2048
    buffer_load_dwordx2 v[110:111], v8, s[12:15], s16 offen offset:2560
    buffer_load_dwordx2 v[112:113], v8, s[12:15], s16 offen offset:3072
    buffer_load_dwordx2 v[114:115], v8, s[12:15], s16 offen offset:3584
    s_mov_b32 s16, 2756608
    buffer_load_dwordx2 v[116:117], v8, s[12:15], s16 offen offset:0
    buffer_load_dwordx2 v[118:119], v8, s[12:15], s16 offen offset:512
    buffer_load_dwordx2 v[120:121], v8, s[12:15], s16 offen offset:1024
    buffer_load_dwordx2 v[122:123], v8, s[12:15], s16 offen offset:1536
    buffer_load_dwordx2 v[124:125], v8, s[12:15], s16 offen offset:2048
    buffer_load_dwordx2 v[126:127], v8, s[12:15], s16 offen offset:2560
    buffer_load_dwordx2 v[128:129], v8, s[12:15], s16 offen offset:3072
    buffer_load_dwordx2 v[130:131], v8, s[12:15], s16 offen offset:3584
    s_mov_b32 s16, 2760704
    buffer_load_dwordx2 v[132:133], v8, s[12:15], s16 offen offset:0
    buffer_load_dwordx2 v[134:135], v8, s[12:15], s16 offen offset:512
    buffer_load_dwordx2 v[136:137], v8, s[12:15], s16 offen offset:1024
    buffer_load_dwordx2 v[138:139], v8, s[12:15], s16 offen offset:1536
    v_mov_b32 v140, 0
    v_mov_b32 v141, 0
    v_mov_b32 v142, 0
    v_mov_b32 v143, 0
    v_mov_b32 v144, 0
    v_mov_b32 v145, 0
    v_mov_b32 v146, 0
    v_mov_b32 v147, 0
    v_mov_b32 v148, 0
    v_mov_b32 v149, 0
    v_mov_b32 v150, 0
    v_mov_b32 v151, 0
    v_mov_b32 v152, 0
    v_mov_b32 v153, 0
    v_mov_b32 v154, 0
    v_mov_b32 v155, 0
    v_mov_b32 v156, 0
    v_mov_b32 v157, 0
    v_mov_b32 v158, 0
    v_mov_b32 v159, 0
    v_mov_b32 v160, 0
    v_mov_b32 v161, 0
    v_mov_b32 v162, 0
    v_mov_b32 v163, 0
    v_mov_b32 v164, 0
    v_mov_b32 v165, 0
    v_mov_b32 v166, 0
    v_mov_b32 v167, 0
    v_mov_b32 v168, 0
    v_mov_b32 v169, 0
    v_mov_b32 v170, 0
    v_mov_b32 v171, 0
    v_mov_b32 v172, 0
    v_mov_b32 v173, 0
    v_mov_b32 v174, 0
    v_mov_b32 v175, 0
    v_mov_b32 v176, 0
    v_mov_b32 v177, 0
    v_mov_b32 v178, 0
    v_mov_b32 v179, 0
    v_mov_b32 v180, 0
    v_mov_b32 v181, 0
    v_mov_b32 v182, 0
    v_mov_b32 v183, 0
    v_and_b32 v14, 3, v1
    v_lshlrev_b32 v15, 3, v4
    v_lshlrev_b32 v16, 3, v3
    s_waitcnt vmcnt(0)
    v_readlane_b32 s40, v10, 0
    v_readlane_b32 s41, v10, 16
    v_readlane_b32 s42, v10, 32
    v_readlane_b32 s43, v10, 48
    v_lshlrev_b32 v28, 12, v2
    v_add_u32 v28, 22784, v28
    v_lshl_add_u32 v29, v1, 4, v28
    s_mov_b32 s44, 0
L_m_chunk:
    v_sub_u32 v34, v11, v10
    v_sub_u32 v35, v13, v12
    v_subrev_u32 v34, s44, v34
    v_subrev_u32 v35, s44, v35
    v_cmp_lt_i32 vcc, 0, v34
    s_cbranch_vccz L_m_done
    v_max_i32 v34, 0, v34
    v_max_i32 v35, 0, v35
    v_min_u32 v34, 64, v34
    v_min_u32 v35, 64, v35
    s_mov_b32 s16, 4194304
    s_add_u32 s45, s40, s44
    v_add_u32 v17, s45, v1
    v_min_u32 v17, 639999, v17
    v_lshlrev_b32 v17, 4, v17
    buffer_load_dwordx4 v[184:187], v17, s[12:15], s16 offen
    s_add_u32 s45, s41, s44
    v_add_u32 v17, s45, v1
    v_min_u32 v17, 639999, v17
    v_lshlrev_b32 v17, 4, v17
    buffer_load_dwordx4 v[188:191], v17, s[12:15], s16 offen
    s_add_u32 s45, s42, s44
    v_add_u32 v17, s45, v1
    v_min_u32 v17, 639999, v17
    v_lshlrev_b32 v17, 4, v17
    buffer_load_dwordx4 v[192:195], v17, s[12:15], s16 offen
    s_add_u32 s45, s43, s44
    v_add_u32 v17, s45, v1
    v_min_u32 v17, 639999, v17
    v_lshlrev_b32 v17, 4, v17
    buffer_load_dwordx4 v[196:199], v17, s[12:15], s16 offen
    s_waitcnt vmcnt(0)
    ds_write_b128 v29, v[184:187] offset:0
    ds_write_b128 v29, v[188:191] offset:1024
    ds_write_b128 v29, v[192:195] offset:2048
    ds_write_b128 v29, v[196:199] offset:3072
    v_lshl_add_u32 v30, v4, 10, v28
    v_lshrrev_b32 v31, 2, v3
    v_lshl_add_u32 v31, v31, 10, v28
    v_lshl_add_u32 v31, v14, 4, v31
    v_mov_b32 v32, 0
    v_mov_b32 v33, v14
    s_waitcnt lgkmcnt(0)
    ds_read_b128 v[184:187], v30 offset:0
    ds_read_b128 v[188:191], v30 offset:16
    ds_read_b128 v[192:195], v30 offset:32
    ds_read_b128 v[196:199], v30 offset:48
    ds_read_b32 v18, v31 offset:4
    s_waitcnt lgkmcnt(0)
    v_lshl_add_u32 v18, v18, 5, v15
    buffer_load_dwordx2 v[20:21], v18, s[28:31], 0 offen
    v_lshl_add_u32 v17, v184, 9, v16
    buffer_load_dwordx2 v[36:37], v17, s[8:11], 0 offen offset:0
    buffer_load_dwordx2 v[38:39], v17, s[8:11], 0 offen offset:128
    buffer_load_dwordx2 v[40:41], v17, s[8:11], 0 offen offset:256
    buffer_load_dwordx2 v[42:43], v17, s[8:11], 0 offen offset:384
    v_lshlrev_b32 v232, 16, v186
    v_and_b32 v233, 0xffff0000, v186
    v_lshlrev_b32 v234, 16, v187
    v_lshl_add_u32 v17, v188, 9, v16
    buffer_load_dwordx2 v[44:45], v17, s[8:11], 0 offen offset:0
    buffer_load_dwordx2 v[46:47], v17, s[8:11], 0 offen offset:128
    buffer_load_dwordx2 v[48:49], v17, s[8:11], 0 offen offset:256
    buffer_load_dwordx2 v[50:51], v17, s[8:11], 0 offen offset:384
    v_lshlrev_b32 v235, 16, v190
    v_and_b32 v236, 0xffff0000, v190
    v_lshlrev_b32 v237, 16, v191
    v_lshl_add_u32 v17, v192, 9, v16
    buffer_load_dwordx2 v[52:53], v17, s[8:11], 0 offen offset:0
    buffer_load_dwordx2 v[54:55], v17, s[8:11], 0 offen offset:128
    buffer_load_dwordx2 v[56:57], v17, s[8:11], 0 offen offset:256
    buffer_load_dwordx2 v[58:59], v17, s[8:11], 0 offen offset:384
    v_lshlrev_b32 v238, 16, v194
    v_and_b32 v239, 0xffff0000, v194
    v_lshlrev_b32 v240, 16, v195
    v_lshl_add_u32 v17, v196, 9, v16
    buffer_load_dwordx2 v[60:61], v17, s[8:11], 0 offen offset:0
    buffer_load_dwordx2 v[62:63], v17, s[8:11], 0 offen offset:128
    buffer_load_dwordx2 v[64:65], v17, s[8:11], 0 offen offset:256
    buffer_load_dwordx2 v[66:67], v17, s[8:11], 0 offen offset:384
    v_lshlrev_b32 v241, 16, v198
    v_and_b32 v242, 0xffff0000, v198
    v_lshlrev_b32 v243, 16, v199
    v_add_u32 v30, 64, v30
    v_add_u32 v31, 64, v31
L_m_loop:
    v_cmp_lt_u32 vcc, v32, v34
    s_cbranch_vccz L_m_next
    ds_read_b128 v[184:187], v30 offset:0
    ds_read_b128 v[188:191], v30 offset:16
    ds_read_b128 v[192:195], v30 offset:32
    ds_read_b128 v[196:199], v30 offset:48
    ds_read_b32 v18, v31 offset:4
    s_waitcnt lgkmcnt(0)
    v_lshl_add_u32 v18, v18, 5, v15
    buffer_load_dwordx2 v[26:27], v18, s[28:31], 0 offen
    v_lshl_add_u32 v17, v184, 9, v16
    buffer_load_dwordx2 v[68:69], v17, s[8:11], 0 offen offset:0
    buffer_load_dwordx2 v[70:71], v17, s[8:11], 0 offen offset:128
    buffer_load_dwordx2 v[72:73], v17, s[8:11], 0 offen offset:256
    buffer_load_dwordx2 v[74:75], v17, s[8:11], 0 offen offset:384
    v_lshlrev_b32 v244, 16, v186
    v_and_b32 v245, 0xffff0000, v186
    v_lshlrev_b32 v246, 16, v187
    v_lshl_add_u32 v17, v188, 9, v16
    buffer_load_dwordx2 v[76:77], v17, s[8:11], 0 offen offset:0
    buffer_load_dwordx2 v[78:79], v17, s[8:11], 0 offen offset:128
    buffer_load_dwordx2 v[80:81], v17, s[8:11], 0 offen offset:256
    buffer_load_dwordx2 v[82:83], v17, s[8:11], 0 offen offset:384
    v_lshlrev_b32 v247, 16, v190
    v_and_b32 v248, 0xffff0000, v190
    v_lshlrev_b32 v249, 16, v191
    v_lshl_add_u32 v17, v192, 9, v16
    buffer_load_dwordx2 v[84:85], v17, s[8:11], 0 offen offset:0
    buffer_load_dwordx2 v[86:87], v17, s[8:11], 0 offen offset:128
    buffer_load_dwordx2 v[88:89], v17, s[8:11], 0 offen offset:256
    buffer_load_dwordx2 v[90:91], v17, s[8:11], 0 offen offset:384
    v_lshlrev_b32 v250, 16, v194
    v_and_b32 v251, 0xffff0000, v194
    v_lshlrev_b32 v252, 16, v195
    v_lshl_add_u32 v17, v196, 9, v16
    buffer_load_dwordx2 v[92:93], v17, s[8:11], 0 offen offset:0
    buffer_load_dwordx2 v[94:95], v17, s[8:11], 0 offen offset:128
    buffer_load_dwordx2 v[96:97], v17, s[8:11], 0 offen offset:256
    buffer_load_dwordx2 v[98:99], v17, s[8:11], 0 offen offset:384
    v_lshlrev_b32 v253, 16, v198
    v_and_b32 v254, 0xffff0000, v198
    v_lshlrev_b32 v255, 16, v199
    v_add_u32 v30, 64, v30
    v_add_u32 v31, 64, v31
    s_waitcnt vmcnt(17)
    v_cmp_lt_u32 vcc, v33, v35
    s_nop 1
    v_cndmask_b32 v20, 0, v20, vcc
    v_cndmask_b32 v21, 0, v21, vcc
    s_nop 1
    v_mfma_f32_16x16x16_bf16 v[184:187], v[20:21], v[100:101], 0
    v_mfma_f32_16x16x16_bf16 v[188:191], v[20:21], v[102:103], 0
    v_mfma_f32_16x16x16_bf16 v[192:195], v[20:21], v[104:105], 0
    v_mfma_f32_16x16x16_bf16 v[196:199], v[20:21], v[106:107], 0
    v_mfma_f32_16x16x16_bf16 v[200:203], v[20:21], v[116:117], 0
    v_mfma_f32_16x16x16_bf16 v[204:207], v[20:21], v[118:119], 0
    v_mfma_f32_16x16x16_bf16 v[208:211], v[20:21], v[120:121], 0
    v_mfma_f32_16x16x16_bf16 v[212:215], v[20:21], v[122:123], 0
    s_nop 7
    v_lshlrev_b32 v22, 16, v36
    v_fmac_f32 v140, v22, v184
    v_mul_f32 v23, v22, v200
    v_fmac_f32 v148, v23, v232
    v_fmac_f32 v152, v23, v233
    v_fmac_f32 v156, v23, v234
    v_and_b32 v22, 0xffff0000, v36
    v_fmac_f32 v141, v22, v188
    v_mul_f32 v23, v22, v204
    v_fmac_f32 v149, v23, v232
    v_fmac_f32 v153, v23, v233
    v_fmac_f32 v157, v23, v234
    v_lshlrev_b32 v22, 16, v37
    v_fmac_f32 v142, v22, v192
    v_mul_f32 v23, v22, v208
    v_fmac_f32 v150, v23, v232
    v_fmac_f32 v154, v23, v233
    v_fmac_f32 v158, v23, v234
    v_and_b32 v22, 0xffff0000, v37
    v_fmac_f32 v143, v22, v196
    v_mul_f32 v23, v22, v212
    v_fmac_f32 v151, v23, v232
    v_fmac_f32 v155, v23, v233
    v_fmac_f32 v159, v23, v234
    v_lshlrev_b32 v22, 16, v44
    v_fmac_f32 v140, v22, v185
    v_mul_f32 v23, v22, v201
    v_fmac_f32 v148, v23, v235
    v_fmac_f32 v152, v23, v236
    v_fmac_f32 v156, v23, v237
    v_and_b32 v22, 0xffff0000, v44
    v_fmac_f32 v141, v22, v189
    v_mul_f32 v23, v22, v205
    v_fmac_f32 v149, v23, v235
    v_fmac_f32 v153, v23, v236
    v_fmac_f32 v157, v23, v237
    v_lshlrev_b32 v22, 16, v45
    v_fmac_f32 v142, v22, v193
    v_mul_f32 v23, v22, v209
    v_fmac_f32 v150, v23, v235
    v_fmac_f32 v154, v23, v236
    v_fmac_f32 v158, v23, v237
    v_and_b32 v22, 0xffff0000, v45
    v_fmac_f32 v143, v22, v197
    v_mul_f32 v23, v22, v213
    v_fmac_f32 v151, v23, v235
    v_fmac_f32 v155, v23, v236
    v_fmac_f32 v159, v23, v237
    v_lshlrev_b32 v22, 16, v52
    v_fmac_f32 v140, v22, v186
    v_mul_f32 v23, v22, v202
    v_fmac_f32 v148, v23, v238
    v_fmac_f32 v152, v23, v239
    v_fmac_f32 v156, v23, v240
    v_and_b32 v22, 0xffff0000, v52
    v_fmac_f32 v141, v22, v190
    v_mul_f32 v23, v22, v206
    v_fmac_f32 v149, v23, v238
    v_fmac_f32 v153, v23, v239
    v_fmac_f32 v157, v23, v240
    v_lshlrev_b32 v22, 16, v53
    v_fmac_f32 v142, v22, v194
    v_mul_f32 v23, v22, v210
    v_fmac_f32 v150, v23, v238
    v_fmac_f32 v154, v23, v239
    v_fmac_f32 v158, v23, v240
    v_and_b32 v22, 0xffff0000, v53
    v_fmac_f32 v143, v22, v198
    v_mul_f32 v23, v22, v214
    v_fmac_f32 v151, v23, v238
    v_fmac_f32 v155, v23, v239
    v_fmac_f32 v159, v23, v240
    v_lshlrev_b32 v22, 16, v60
    v_fmac_f32 v140, v22, v187
    v_mul_f32 v23, v22, v203
    v_fmac_f32 v148, v23, v241
    v_fmac_f32 v152, v23, v242
    v_fmac_f32 v156, v23, v243
    v_and_b32 v22, 0xffff0000, v60
    v_fmac_f32 v141, v22, v191
    v_mul_f32 v23, v22, v207
    v_fmac_f32 v149, v23, v241
    v_fmac_f32 v153, v23, v242
    v_fmac_f32 v157, v23, v243
    v_lshlrev_b32 v22, 16, v61
    v_fmac_f32 v142, v22, v195
    v_mul_f32 v23, v22, v211
    v_fmac_f32 v150, v23, v241
    v_fmac_f32 v154, v23, v242
    v_fmac_f32 v158, v23, v243
    v_and_b32 v22, 0xffff0000, v61
    v_fmac_f32 v143, v22, v199
    v_mul_f32 v23, v22, v215
    v_fmac_f32 v151, v23, v241
    v_fmac_f32 v155, v23, v242
    v_fmac_f32 v159, v23, v243
    v_mfma_f32_16x16x16_bf16 v[184:187], v[20:21], v[108:109], 0
    v_mfma_f32_16x16x16_bf16 v[188:191], v[20:21], v[110:111], 0
    v_mfma_f32_16x16x16_bf16 v[192:195], v[20:21], v[112:113], 0
    v_mfma_f32_16x16x16_bf16 v[196:199], v[20:21], v[114:115], 0
    v_mfma_f32_16x16x16_bf16 v[200:203], v[20:21], v[124:125], 0
    v_mfma_f32_16x16x16_bf16 v[204:207], v[20:21], v[126:127], 0
    v_mfma_f32_16x16x16_bf16 v[208:211], v[20:21], v[128:129], 0
    v_mfma_f32_16x16x16_bf16 v[212:215], v[20:21], v[130:131], 0
    v_mfma_f32_16x16x16_bf16 v[216:219], v[20:21], v[132:133], 0
    v_mfma_f32_16x16x16_bf16 v[220:223], v[20:21], v[134:135], 0
    v_mfma_f32_16x16x16_bf16 v[224:227], v[20:21], v[136:137], 0
    v_mfma_f32_16x16x16_bf16 v[228:231], v[20:21], v[138:139], 0
    s_nop 7
    v_lshlrev_b32 v22, 16, v38
    v_lshlrev_b32 v23, 16, v40
    v_lshlrev_b32 v24, 16, v42
    v_mul_f32 v25, v22, v232
    v_fmac_f32 v25, v23, v233
    v_fmac_f32 v25, v24, v234
    v_fmac_f32 v144, v25, v184
    v_fmac_f32 v160, v22, v200
    v_fmac_f32 v164, v23, v200
    v_fmac_f32 v168, v24, v200
    v_mul_f32 v25, v234, v23
    v_fma_f32 v25, v233, v24, -v25
    v_fmac_f32 v172, v25, v216
    v_mul_f32 v25, v232, v24
    v_fma_f32 v25, v234, v22, -v25
    v_fmac_f32 v176, v25, v216
    v_mul_f32 v25, v233, v22
    v_fma_f32 v25, v232, v23, -v25
    v_fmac_f32 v180, v25, v216
    v_and_b32 v22, 0xffff0000, v38
    v_and_b32 v23, 0xffff0000, v40
    v_and_b32 v24, 0xffff0000, v42
    v_mul_f32 v25, v22, v232
    v_fmac_f32 v25, v23, v233
    v_fmac_f32 v25, v24, v234
    v_fmac_f32 v145, v25, v188
    v_fmac_f32 v161, v22, v204
    v_fmac_f32 v165, v23, v204
    v_fmac_f32 v169, v24, v204
    v_mul_f32 v25, v234, v23
    v_fma_f32 v25, v233, v24, -v25
    v_fmac_f32 v173, v25, v220
    v_mul_f32 v25, v232, v24
    v_fma_f32 v25, v234, v22, -v25
    v_fmac_f32 v177, v25, v220
    v_mul_f32 v25, v233, v22
    v_fma_f32 v25, v232, v23, -v25
    v_fmac_f32 v181, v25, v220
    v_lshlrev_b32 v22, 16, v39
    v_lshlrev_b32 v23, 16, v41
    v_lshlrev_b32 v24, 16, v43
    v_mul_f32 v25, v22, v232
    v_fmac_f32 v25, v23, v233
    v_fmac_f32 v25, v24, v234
    v_fmac_f32 v146, v25, v192
    v_fmac_f32 v162, v22, v208
    v_fmac_f32 v166, v23, v208
    v_fmac_f32 v170, v24, v208
    v_mul_f32 v25, v234, v23
    v_fma_f32 v25, v233, v24, -v25
    v_fmac_f32 v174, v25, v224
    v_mul_f32 v25, v232, v24
    v_fma_f32 v25, v234, v22, -v25
    v_fmac_f32 v178, v25, v224
    v_mul_f32 v25, v233, v22
    v_fma_f32 v25, v232, v23, -v25
    v_fmac_f32 v182, v25, v224
    v_and_b32 v22, 0xffff0000, v39
    v_and_b32 v23, 0xffff0000, v41
    v_and_b32 v24, 0xffff0000, v43
    v_mul_f32 v25, v22, v232
    v_fmac_f32 v25, v23, v233
    v_fmac_f32 v25, v24, v234
    v_fmac_f32 v147, v25, v196
    v_fmac_f32 v163, v22, v212
    v_fmac_f32 v167, v23, v212
    v_fmac_f32 v171, v24, v212
    v_mul_f32 v25, v234, v23
    v_fma_f32 v25, v233, v24, -v25
    v_fmac_f32 v175, v25, v228
    v_mul_f32 v25, v232, v24
    v_fma_f32 v25, v234, v22, -v25
    v_fmac_f32 v179, v25, v228
    v_mul_f32 v25, v233, v22
    v_fma_f32 v25, v232, v23, -v25
    v_fmac_f32 v183, v25, v228
    v_lshlrev_b32 v22, 16, v46
    v_lshlrev_b32 v23, 16, v48
    v_lshlrev_b32 v24, 16, v50
    v_mul_f32 v25, v22, v235
    v_fmac_f32 v25, v23, v236
    v_fmac_f32 v25, v24, v237
    v_fmac_f32 v144, v25, v185
    v_fmac_f32 v160, v22, v201
    v_fmac_f32 v164, v23, v201
    v_fmac_f32 v168, v24, v201
    v_mul_f32 v25, v237, v23
    v_fma_f32 v25, v236, v24, -v25
    v_fmac_f32 v172, v25, v217
    v_mul_f32 v25, v235, v24
    v_fma_f32 v25, v237, v22, -v25
    v_fmac_f32 v176, v25, v217
    v_mul_f32 v25, v236, v22
    v_fma_f32 v25, v235, v23, -v25
    v_fmac_f32 v180, v25, v217
    v_and_b32 v22, 0xffff0000, v46
    v_and_b32 v23, 0xffff0000, v48
    v_and_b32 v24, 0xffff0000, v50
    v_mul_f32 v25, v22, v235
    v_fmac_f32 v25, v23, v236
    v_fmac_f32 v25, v24, v237
    v_fmac_f32 v145, v25, v189
    v_fmac_f32 v161, v22, v205
    v_fmac_f32 v165, v23, v205
    v_fmac_f32 v169, v24, v205
    v_mul_f32 v25, v237, v23
    v_fma_f32 v25, v236, v24, -v25
    v_fmac_f32 v173, v25, v221
    v_mul_f32 v25, v235, v24
    v_fma_f32 v25, v237, v22, -v25
    v_fmac_f32 v177, v25, v221
    v_mul_f32 v25, v236, v22
    v_fma_f32 v25, v235, v23, -v25
    v_fmac_f32 v181, v25, v221
    v_lshlrev_b32 v22, 16, v47
    v_lshlrev_b32 v23, 16, v49
    v_lshlrev_b32 v24, 16, v51
    v_mul_f32 v25, v22, v235
    v_fmac_f32 v25, v23, v236
    v_fmac_f32 v25, v24, v237
    v_fmac_f32 v146, v25, v193
    v_fmac_f32 v162, v22, v209
    v_fmac_f32 v166, v23, v209
    v_fmac_f32 v170, v24, v209
    v_mul_f32 v25, v237, v23
    v_fma_f32 v25, v236, v24, -v25
    v_fmac_f32 v174, v25, v225
    v_mul_f32 v25, v235, v24
    v_fma_f32 v25, v237, v22, -v25
    v_fmac_f32 v178, v25, v225
    v_mul_f32 v25, v236, v22
    v_fma_f32 v25, v235, v23, -v25
    v_fmac_f32 v182, v25, v225
    v_and_b32 v22, 0xffff0000, v47
    v_and_b32 v23, 0xffff0000, v49
    v_and_b32 v24, 0xffff0000, v51
    v_mul_f32 v25, v22, v235
    v_fmac_f32 v25, v23, v236
    v_fmac_f32 v25, v24, v237
    v_fmac_f32 v147, v25, v197
    v_fmac_f32 v163, v22, v213
    v_fmac_f32 v167, v23, v213
    v_fmac_f32 v171, v24, v213
    v_mul_f32 v25, v237, v23
    v_fma_f32 v25, v236, v24, -v25
    v_fmac_f32 v175, v25, v229
    v_mul_f32 v25, v235, v24
    v_fma_f32 v25, v237, v22, -v25
    v_fmac_f32 v179, v25, v229
    v_mul_f32 v25, v236, v22
    v_fma_f32 v25, v235, v23, -v25
    v_fmac_f32 v183, v25, v229
    v_lshlrev_b32 v22, 16, v54
    v_lshlrev_b32 v23, 16, v56
    v_lshlrev_b32 v24, 16, v58
    v_mul_f32 v25, v22, v238
    v_fmac_f32 v25, v23, v239
    v_fmac_f32 v25, v24, v240
    v_fmac_f32 v144, v25, v186
    v_fmac_f32 v160, v22, v202
    v_fmac_f32 v164, v23, v202
    v_fmac_f32 v168, v24, v202
    v_mul_f32 v25, v240, v23
    v_fma_f32 v25, v239, v24, -v25
    v_fmac_f32 v172, v25, v218
    v_mul_f32 v25, v238, v24
    v_fma_f32 v25, v240, v22, -v25
    v_fmac_f32 v176, v25, v218
    v_mul_f32 v25, v239, v22
    v_fma_f32 v25, v238, v23, -v25
    v_fmac_f32 v180, v25, v218
    v_and_b32 v22, 0xffff0000, v54
    v_and_b32 v23, 0xffff0000, v56
    v_and_b32 v24, 0xffff0000, v58
    v_mul_f32 v25, v22, v238
    v_fmac_f32 v25, v23, v239
    v_fmac_f32 v25, v24, v240
    v_fmac_f32 v145, v25, v190
    v_fmac_f32 v161, v22, v206
    v_fmac_f32 v165, v23, v206
    v_fmac_f32 v169, v24, v206
    v_mul_f32 v25, v240, v23
    v_fma_f32 v25, v239, v24, -v25
    v_fmac_f32 v173, v25, v222
    v_mul_f32 v25, v238, v24
    v_fma_f32 v25, v240, v22, -v25
    v_fmac_f32 v177, v25, v222
    v_mul_f32 v25, v239, v22
    v_fma_f32 v25, v238, v23, -v25
    v_fmac_f32 v181, v25, v222
    v_lshlrev_b32 v22, 16, v55
    v_lshlrev_b32 v23, 16, v57
    v_lshlrev_b32 v24, 16, v59
    v_mul_f32 v25, v22, v238
    v_fmac_f32 v25, v23, v239
    v_fmac_f32 v25, v24, v240
    v_fmac_f32 v146, v25, v194
    v_fmac_f32 v162, v22, v210
    v_fmac_f32 v166, v23, v210
    v_fmac_f32 v170, v24, v210
    v_mul_f32 v25, v240, v23
    v_fma_f32 v25, v239, v24, -v25
    v_fmac_f32 v174, v25, v226
    v_mul_f32 v25, v238, v24
    v_fma_f32 v25, v240, v22, -v25
    v_fmac_f32 v178, v25, v226
    v_mul_f32 v25, v239, v22
    v_fma_f32 v25, v238, v23, -v25
    v_fmac_f32 v182, v25, v226
    v_and_b32 v22, 0xffff0000, v55
    v_and_b32 v23, 0xffff0000, v57
    v_and_b32 v24, 0xffff0000, v59
    v_mul_f32 v25, v22, v238
    v_fmac_f32 v25, v23, v239
    v_fmac_f32 v25, v24, v240
    v_fmac_f32 v147, v25, v198
    v_fmac_f32 v163, v22, v214
    v_fmac_f32 v167, v23, v214
    v_fmac_f32 v171, v24, v214
    v_mul_f32 v25, v240, v23
    v_fma_f32 v25, v239, v24, -v25
    v_fmac_f32 v175, v25, v230
    v_mul_f32 v25, v238, v24
    v_fma_f32 v25, v240, v22, -v25
    v_fmac_f32 v179, v25, v230
    v_mul_f32 v25, v239, v22
    v_fma_f32 v25, v238, v23, -v25
    v_fmac_f32 v183, v25, v230
    v_lshlrev_b32 v22, 16, v62
    v_lshlrev_b32 v23, 16, v64
    v_lshlrev_b32 v24, 16, v66
    v_mul_f32 v25, v22, v241
    v_fmac_f32 v25, v23, v242
    v_fmac_f32 v25, v24, v243
    v_fmac_f32 v144, v25, v187
    v_fmac_f32 v160, v22, v203
    v_fmac_f32 v164, v23, v203
    v_fmac_f32 v168, v24, v203
    v_mul_f32 v25, v243, v23
    v_fma_f32 v25, v242, v24, -v25
    v_fmac_f32 v172, v25, v219
    v_mul_f32 v25, v241, v24
    v_fma_f32 v25, v243, v22, -v25
    v_fmac_f32 v176, v25, v219
    v_mul_f32 v25, v242, v22
    v_fma_f32 v25, v241, v23, -v25
    v_fmac_f32 v180, v25, v219
    v_and_b32 v22, 0xffff0000, v62
    v_and_b32 v23, 0xffff0000, v64
    v_and_b32 v24, 0xffff0000, v66
    v_mul_f32 v25, v22, v241
    v_fmac_f32 v25, v23, v242
    v_fmac_f32 v25, v24, v243
    v_fmac_f32 v145, v25, v191
    v_fmac_f32 v161, v22, v207
    v_fmac_f32 v165, v23, v207
    v_fmac_f32 v169, v24, v207
    v_mul_f32 v25, v243, v23
    v_fma_f32 v25, v242, v24, -v25
    v_fmac_f32 v173, v25, v223
    v_mul_f32 v25, v241, v24
    v_fma_f32 v25, v243, v22, -v25
    v_fmac_f32 v177, v25, v223
    v_mul_f32 v25, v242, v22
    v_fma_f32 v25, v241, v23, -v25
    v_fmac_f32 v181, v25, v223
    v_lshlrev_b32 v22, 16, v63
    v_lshlrev_b32 v23, 16, v65
    v_lshlrev_b32 v24, 16, v67
    v_mul_f32 v25, v22, v241
    v_fmac_f32 v25, v23, v242
    v_fmac_f32 v25, v24, v243
    v_fmac_f32 v146, v25, v195
    v_fmac_f32 v162, v22, v211
    v_fmac_f32 v166, v23, v211
    v_fmac_f32 v170, v24, v211
    v_mul_f32 v25, v243, v23
    v_fma_f32 v25, v242, v24, -v25
    v_fmac_f32 v174, v25, v227
    v_mul_f32 v25, v241, v24
    v_fma_f32 v25, v243, v22, -v25
    v_fmac_f32 v178, v25, v227
    v_mul_f32 v25, v242, v22
    v_fma_f32 v25, v241, v23, -v25
    v_fmac_f32 v182, v25, v227
    v_and_b32 v22, 0xffff0000, v63
    v_and_b32 v23, 0xffff0000, v65
    v_and_b32 v24, 0xffff0000, v67
    v_mul_f32 v25, v22, v241
    v_fmac_f32 v25, v23, v242
    v_fmac_f32 v25, v24, v243
    v_fmac_f32 v147, v25, v199
    v_fmac_f32 v163, v22, v215
    v_fmac_f32 v167, v23, v215
    v_fmac_f32 v171, v24, v215
    v_mul_f32 v25, v243, v23
    v_fma_f32 v25, v242, v24, -v25
    v_fmac_f32 v175, v25, v231
    v_mul_f32 v25, v241, v24
    v_fma_f32 v25, v243, v22, -v25
    v_fmac_f32 v179, v25, v231
    v_mul_f32 v25, v242, v22
    v_fma_f32 v25, v241, v23, -v25
    v_fmac_f32 v183, v25, v231
    v_add_u32 v32, 4, v32
    v_add_u32 v33, 4, v33
    v_cmp_lt_u32 vcc, v32, v34
    s_cbranch_vccz L_m_next
    ds_read_b128 v[184:187], v30 offset:0
    ds_read_b128 v[188:191], v30 offset:16
    ds_read_b128 v[192:195], v30 offset:32
    ds_read_b128 v[196:199], v30 offset:48
    ds_read_b32 v18, v31 offset:4
    s_waitcnt lgkmcnt(0)
    v_lshl_add_u32 v18, v18, 5, v15
    buffer_load_dwordx2 v[20:21], v18, s[28:31], 0 offen
    v_lshl_add_u32 v17, v184, 9, v16
    buffer_load_dwordx2 v[36:37], v17, s[8:11], 0 offen offset:0
    buffer_load_dwordx2 v[38:39], v17, s[8:11], 0 offen offset:128
    buffer_load_dwordx2 v[40:41], v17, s[8:11], 0 offen offset:256
    buffer_load_dwordx2 v[42:43], v17, s[8:11], 0 offen offset:384
    v_lshlrev_b32 v232, 16, v186
    v_and_b32 v233, 0xffff0000, v186
    v_lshlrev_b32 v234, 16, v187
    v_lshl_add_u32 v17, v188, 9, v16
    buffer_load_dwordx2 v[44:45], v17, s[8:11], 0 offen offset:0
    buffer_load_dwordx2 v[46:47], v17, s[8:11], 0 offen offset:128
    buffer_load_dwordx2 v[48:49], v17, s[8:11], 0 offen offset:256
    buffer_load_dwordx2 v[50:51], v17, s[8:11], 0 offen offset:384
    v_lshlrev_b32 v235, 16, v190
    v_and_b32 v236, 0xffff0000, v190
    v_lshlrev_b32 v237, 16, v191
    v_lshl_add_u32 v17, v192, 9, v16
    buffer_load_dwordx2 v[52:53], v17, s[8:11], 0 offen offset:0
    buffer_load_dwordx2 v[54:55], v17, s[8:11], 0 offen offset:128
    buffer_load_dwordx2 v[56:57], v17, s[8:11], 0 offen offset:256
    buffer_load_dwordx2 v[58:59], v17, s[8:11], 0 offen offset:384
    v_lshlrev_b32 v238, 16, v194
    v_and_b32 v239, 0xffff0000, v194
    v_lshlrev_b32 v240, 16, v195
    v_lshl_add_u32 v17, v196, 9, v16
    buffer_load_dwordx2 v[60:61], v17, s[8:11], 0 offen offset:0
    buffer_load_dwordx2 v[62:63], v17, s[8:11], 0 offen offset:128
    buffer_load_dwordx2 v[64:65], v17, s[8:11], 0 offen offset:256
    buffer_load_dwordx2 v[66:67], v17, s[8:11], 0 offen offset:384
    v_lshlrev_b32 v241, 16, v198
    v_and_b32 v242, 0xffff0000, v198
    v_lshlrev_b32 v243, 16, v199
    v_add_u32 v30, 64, v30
    v_add_u32 v31, 64, v31
    s_waitcnt vmcnt(17)
    v_cmp_lt_u32 vcc, v33, v35
    s_nop 1
    v_cndmask_b32 v26, 0, v26, vcc
    v_cndmask_b32 v27, 0, v27, vcc
    s_nop 1
    v_mfma_f32_16x16x16_bf16 v[184:187], v[26:27], v[100:101], 0
    v_mfma_f32_16x16x16_bf16 v[188:191], v[26:27], v[102:103], 0
    v_mfma_f32_16x16x16_bf16 v[192:195], v[26:27], v[104:105], 0
    v_mfma_f32_16x16x16_bf16 v[196:199], v[26:27], v[106:107], 0
    v_mfma_f32_16x16x16_bf16 v[200:203], v[26:27], v[116:117], 0
    v_mfma_f32_16x16x16_bf16 v[204:207], v[26:27], v[118:119], 0
    v_mfma_f32_16x16x16_bf16 v[208:211], v[26:27], v[120:121], 0
    v_mfma_f32_16x16x16_bf16 v[212:215], v[26:27], v[122:123], 0
    s_nop 7
    v_lshlrev_b32 v22, 16, v68
    v_fmac_f32 v140, v22, v184
    v_mul_f32 v23, v22, v200
    v_fmac_f32 v148, v23, v244
    v_fmac_f32 v152, v23, v245
    v_fmac_f32 v156, v23, v246
    v_and_b32 v22, 0xffff0000, v68
    v_fmac_f32 v141, v22, v188
    v_mul_f32 v23, v22, v204
    v_fmac_f32 v149, v23, v244
    v_fmac_f32 v153, v23, v245
    v_fmac_f32 v157, v23, v246
    v_lshlrev_b32 v22, 16, v69
    v_fmac_f32 v142, v22, v192
    v_mul_f32 v23, v22, v208
    v_fmac_f32 v150, v23, v244
    v_fmac_f32 v154, v23, v245
    v_fmac_f32 v158, v23, v246
    v_and_b32 v22, 0xffff0000, v69
    v_fmac_f32 v143, v22, v196
    v_mul_f32 v23, v22, v212
    v_fmac_f32 v151, v23, v244
    v_fmac_f32 v155, v23, v245
    v_fmac_f32 v159, v23, v246
    v_lshlrev_b32 v22, 16, v76
    v_fmac_f32 v140, v22, v185
    v_mul_f32 v23, v22, v201
    v_fmac_f32 v148, v23, v247
    v_fmac_f32 v152, v23, v248
    v_fmac_f32 v156, v23, v249
    v_and_b32 v22, 0xffff0000, v76
    v_fmac_f32 v141, v22, v189
    v_mul_f32 v23, v22, v205
    v_fmac_f32 v149, v23, v247
    v_fmac_f32 v153, v23, v248
    v_fmac_f32 v157, v23, v249
    v_lshlrev_b32 v22, 16, v77
    v_fmac_f32 v142, v22, v193
    v_mul_f32 v23, v22, v209
    v_fmac_f32 v150, v23, v247
    v_fmac_f32 v154, v23, v248
    v_fmac_f32 v158, v23, v249
    v_and_b32 v22, 0xffff0000, v77
    v_fmac_f32 v143, v22, v197
    v_mul_f32 v23, v22, v213
    v_fmac_f32 v151, v23, v247
    v_fmac_f32 v155, v23, v248
    v_fmac_f32 v159, v23, v249
    v_lshlrev_b32 v22, 16, v84
    v_fmac_f32 v140, v22, v186
    v_mul_f32 v23, v22, v202
    v_fmac_f32 v148, v23, v250
    v_fmac_f32 v152, v23, v251
    v_fmac_f32 v156, v23, v252
    v_and_b32 v22, 0xffff0000, v84
    v_fmac_f32 v141, v22, v190
    v_mul_f32 v23, v22, v206
    v_fmac_f32 v149, v23, v250
    v_fmac_f32 v153, v23, v251
    v_fmac_f32 v157, v23, v252
    v_lshlrev_b32 v22, 16, v85
    v_fmac_f32 v142, v22, v194
    v_mul_f32 v23, v22, v210
    v_fmac_f32 v150, v23, v250
    v_fmac_f32 v154, v23, v251
    v_fmac_f32 v158, v23, v252
    v_and_b32 v22, 0xffff0000, v85
    v_fmac_f32 v143, v22, v198
    v_mul_f32 v23, v22, v214
    v_fmac_f32 v151, v23, v250
    v_fmac_f32 v155, v23, v251
    v_fmac_f32 v159, v23, v252
    v_lshlrev_b32 v22, 16, v92
    v_fmac_f32 v140, v22, v187
    v_mul_f32 v23, v22, v203
    v_fmac_f32 v148, v23, v253
    v_fmac_f32 v152, v23, v254
    v_fmac_f32 v156, v23, v255
    v_and_b32 v22, 0xffff0000, v92
    v_fmac_f32 v141, v22, v191
    v_mul_f32 v23, v22, v207
    v_fmac_f32 v149, v23, v253
    v_fmac_f32 v153, v23, v254
    v_fmac_f32 v157, v23, v255
    v_lshlrev_b32 v22, 16, v93
    v_fmac_f32 v142, v22, v195
    v_mul_f32 v23, v22, v211
    v_fmac_f32 v150, v23, v253
    v_fmac_f32 v154, v23, v254
    v_fmac_f32 v158, v23, v255
    v_and_b32 v22, 0xffff0000, v93
    v_fmac_f32 v143, v22, v199
    v_mul_f32 v23, v22, v215
    v_fmac_f32 v151, v23, v253
    v_fmac_f32 v155, v23, v254
    v_fmac_f32 v159, v23, v255
    v_mfma_f32_16x16x16_bf16 v[184:187], v[26:27], v[108:109], 0
    v_mfma_f32_16x16x16_bf16 v[188:191], v[26:27], v[110:111], 0
    v_mfma_f32_16x16x16_bf16 v[192:195], v[26:27], v[112:113], 0
    v_mfma_f32_16x16x16_bf16 v[196:199], v[26:27], v[114:115], 0
    v_mfma_f32_16x16x16_bf16 v[200:203], v[26:27], v[124:125], 0
    v_mfma_f32_16x16x16_bf16 v[204:207], v[26:27], v[126:127], 0
    v_mfma_f32_16x16x16_bf16 v[208:211], v[26:27], v[128:129], 0
    v_mfma_f32_16x16x16_bf16 v[212:215], v[26:27], v[130:131], 0
    v_mfma_f32_16x16x16_bf16 v[216:219], v[26:27], v[132:133], 0
    v_mfma_f32_16x16x16_bf16 v[220:223], v[26:27], v[134:135], 0
    v_mfma_f32_16x16x16_bf16 v[224:227], v[26:27], v[136:137], 0
    v_mfma_f32_16x16x16_bf16 v[228:231], v[26:27], v[138:139], 0
    s_nop 7
    v_lshlrev_b32 v22, 16, v70
    v_lshlrev_b32 v23, 16, v72
    v_lshlrev_b32 v24, 16, v74
    v_mul_f32 v25, v22, v244
    v_fmac_f32 v25, v23, v245
    v_fmac_f32 v25, v24, v246
    v_fmac_f32 v144, v25, v184
    v_fmac_f32 v160, v22, v200
    v_fmac_f32 v164, v23, v200
    v_fmac_f32 v168, v24, v200
    v_mul_f32 v25, v246, v23
    v_fma_f32 v25, v245, v24, -v25
    v_fmac_f32 v172, v25, v216
    v_mul_f32 v25, v244, v24
    v_fma_f32 v25, v246, v22, -v25
    v_fmac_f32 v176, v25, v216
    v_mul_f32 v25, v245, v22
    v_fma_f32 v25, v244, v23, -v25
    v_fmac_f32 v180, v25, v216
    v_and_b32 v22, 0xffff0000, v70
    v_and_b32 v23, 0xffff0000, v72
    v_and_b32 v24, 0xffff0000, v74
    v_mul_f32 v25, v22, v244
    v_fmac_f32 v25, v23, v245
    v_fmac_f32 v25, v24, v246
    v_fmac_f32 v145, v25, v188
    v_fmac_f32 v161, v22, v204
    v_fmac_f32 v165, v23, v204
    v_fmac_f32 v169, v24, v204
    v_mul_f32 v25, v246, v23
    v_fma_f32 v25, v245, v24, -v25
    v_fmac_f32 v173, v25, v220
    v_mul_f32 v25, v244, v24
    v_fma_f32 v25, v246, v22, -v25
    v_fmac_f32 v177, v25, v220
    v_mul_f32 v25, v245, v22
    v_fma_f32 v25, v244, v23, -v25
    v_fmac_f32 v181, v25, v220
    v_lshlrev_b32 v22, 16, v71
    v_lshlrev_b32 v23, 16, v73
    v_lshlrev_b32 v24, 16, v75
    v_mul_f32 v25, v22, v244
    v_fmac_f32 v25, v23, v245
    v_fmac_f32 v25, v24, v246
    v_fmac_f32 v146, v25, v192
    v_fmac_f32 v162, v22, v208
    v_fmac_f32 v166, v23, v208
    v_fmac_f32 v170, v24, v208
    v_mul_f32 v25, v246, v23
    v_fma_f32 v25, v245, v24, -v25
    v_fmac_f32 v174, v25, v224
    v_mul_f32 v25, v244, v24
    v_fma_f32 v25, v246, v22, -v25
    v_fmac_f32 v178, v25, v224
    v_mul_f32 v25, v245, v22
    v_fma_f32 v25, v244, v23, -v25
    v_fmac_f32 v182, v25, v224
    v_and_b32 v22, 0xffff0000, v71
    v_and_b32 v23, 0xffff0000, v73
    v_and_b32 v24, 0xffff0000, v75
    v_mul_f32 v25, v22, v244
    v_fmac_f32 v25, v23, v245
    v_fmac_f32 v25, v24, v246
    v_fmac_f32 v147, v25, v196
    v_fmac_f32 v163, v22, v212
    v_fmac_f32 v167, v23, v212
    v_fmac_f32 v171, v24, v212
    v_mul_f32 v25, v246, v23
    v_fma_f32 v25, v245, v24, -v25
    v_fmac_f32 v175, v25, v228
    v_mul_f32 v25, v244, v24
    v_fma_f32 v25, v246, v22, -v25
    v_fmac_f32 v179, v25, v228
    v_mul_f32 v25, v245, v22
    v_fma_f32 v25, v244, v23, -v25
    v_fmac_f32 v183, v25, v228
    v_lshlrev_b32 v22, 16, v78
    v_lshlrev_b32 v23, 16, v80
    v_lshlrev_b32 v24, 16, v82
    v_mul_f32 v25, v22, v247
    v_fmac_f32 v25, v23, v248
    v_fmac_f32 v25, v24, v249
    v_fmac_f32 v144, v25, v185
    v_fmac_f32 v160, v22, v201
    v_fmac_f32 v164, v23, v201
    v_fmac_f32 v168, v24, v201
    v_mul_f32 v25, v249, v23
    v_fma_f32 v25, v248, v24, -v25
    v_fmac_f32 v172, v25, v217
    v_mul_f32 v25, v247, v24
    v_fma_f32 v25, v249, v22, -v25
    v_fmac_f32 v176, v25, v217
    v_mul_f32 v25, v248, v22
    v_fma_f32 v25, v247, v23, -v25
    v_fmac_f32 v180, v25, v217
    v_and_b32 v22, 0xffff0000, v78
    v_and_b32 v23, 0xffff0000, v80
    v_and_b32 v24, 0xffff0000, v82
    v_mul_f32 v25, v22, v247
    v_fmac_f32 v25, v23, v248
    v_fmac_f32 v25, v24, v249
    v_fmac_f32 v145, v25, v189
    v_fmac_f32 v161, v22, v205
    v_fmac_f32 v165, v23, v205
    v_fmac_f32 v169, v24, v205
    v_mul_f32 v25, v249, v23
    v_fma_f32 v25, v248, v24, -v25
    v_fmac_f32 v173, v25, v221
    v_mul_f32 v25, v247, v24
    v_fma_f32 v25, v249, v22, -v25
    v_fmac_f32 v177, v25, v221
    v_mul_f32 v25, v248, v22
    v_fma_f32 v25, v247, v23, -v25
    v_fmac_f32 v181, v25, v221
    v_lshlrev_b32 v22, 16, v79
    v_lshlrev_b32 v23, 16, v81
    v_lshlrev_b32 v24, 16, v83
    v_mul_f32 v25, v22, v247
    v_fmac_f32 v25, v23, v248
    v_fmac_f32 v25, v24, v249
    v_fmac_f32 v146, v25, v193
    v_fmac_f32 v162, v22, v209
    v_fmac_f32 v166, v23, v209
    v_fmac_f32 v170, v24, v209
    v_mul_f32 v25, v249, v23
    v_fma_f32 v25, v248, v24, -v25
    v_fmac_f32 v174, v25, v225
    v_mul_f32 v25, v247, v24
    v_fma_f32 v25, v249, v22, -v25
    v_fmac_f32 v178, v25, v225
    v_mul_f32 v25, v248, v22
    v_fma_f32 v25, v247, v23, -v25
    v_fmac_f32 v182, v25, v225
    v_and_b32 v22, 0xffff0000, v79
    v_and_b32 v23, 0xffff0000, v81
    v_and_b32 v24, 0xffff0000, v83
    v_mul_f32 v25, v22, v247
    v_fmac_f32 v25, v23, v248
    v_fmac_f32 v25, v24, v249
    v_fmac_f32 v147, v25, v197
    v_fmac_f32 v163, v22, v213
    v_fmac_f32 v167, v23, v213
    v_fmac_f32 v171, v24, v213
    v_mul_f32 v25, v249, v23
    v_fma_f32 v25, v248, v24, -v25
    v_fmac_f32 v175, v25, v229
    v_mul_f32 v25, v247, v24
    v_fma_f32 v25, v249, v22, -v25
    v_fmac_f32 v179, v25, v229
    v_mul_f32 v25, v248, v22
    v_fma_f32 v25, v247, v23, -v25
    v_fmac_f32 v183, v25, v229
    v_lshlrev_b32 v22, 16, v86
    v_lshlrev_b32 v23, 16, v88
    v_lshlrev_b32 v24, 16, v90
    v_mul_f32 v25, v22, v250
    v_fmac_f32 v25, v23, v251
    v_fmac_f32 v25, v24, v252
    v_fmac_f32 v144, v25, v186
    v_fmac_f32 v160, v22, v202
    v_fmac_f32 v164, v23, v202
    v_fmac_f32 v168, v24, v202
    v_mul_f32 v25, v252, v23
    v_fma_f32 v25, v251, v24, -v25
    v_fmac_f32 v172, v25, v218
    v_mul_f32 v25, v250, v24
    v_fma_f32 v25, v252, v22, -v25
    v_fmac_f32 v176, v25, v218
    v_mul_f32 v25, v251, v22
    v_fma_f32 v25, v250, v23, -v25
    v_fmac_f32 v180, v25, v218
    v_and_b32 v22, 0xffff0000, v86
    v_and_b32 v23, 0xffff0000, v88
    v_and_b32 v24, 0xffff0000, v90
    v_mul_f32 v25, v22, v250
    v_fmac_f32 v25, v23, v251
    v_fmac_f32 v25, v24, v252
    v_fmac_f32 v145, v25, v190
    v_fmac_f32 v161, v22, v206
    v_fmac_f32 v165, v23, v206
    v_fmac_f32 v169, v24, v206
    v_mul_f32 v25, v252, v23
    v_fma_f32 v25, v251, v24, -v25
    v_fmac_f32 v173, v25, v222
    v_mul_f32 v25, v250, v24
    v_fma_f32 v25, v252, v22, -v25
    v_fmac_f32 v177, v25, v222
    v_mul_f32 v25, v251, v22
    v_fma_f32 v25, v250, v23, -v25
    v_fmac_f32 v181, v25, v222
    v_lshlrev_b32 v22, 16, v87
    v_lshlrev_b32 v23, 16, v89
    v_lshlrev_b32 v24, 16, v91
    v_mul_f32 v25, v22, v250
    v_fmac_f32 v25, v23, v251
    v_fmac_f32 v25, v24, v252
    v_fmac_f32 v146, v25, v194
    v_fmac_f32 v162, v22, v210
    v_fmac_f32 v166, v23, v210
    v_fmac_f32 v170, v24, v210
    v_mul_f32 v25, v252, v23
    v_fma_f32 v25, v251, v24, -v25
    v_fmac_f32 v174, v25, v226
    v_mul_f32 v25, v250, v24
    v_fma_f32 v25, v252, v22, -v25
    v_fmac_f32 v178, v25, v226
    v_mul_f32 v25, v251, v22
    v_fma_f32 v25, v250, v23, -v25
    v_fmac_f32 v182, v25, v226
    v_and_b32 v22, 0xffff0000, v87
    v_and_b32 v23, 0xffff0000, v89
    v_and_b32 v24, 0xffff0000, v91
    v_mul_f32 v25, v22, v250
    v_fmac_f32 v25, v23, v251
    v_fmac_f32 v25, v24, v252
    v_fmac_f32 v147, v25, v198
    v_fmac_f32 v163, v22, v214
    v_fmac_f32 v167, v23, v214
    v_fmac_f32 v171, v24, v214
    v_mul_f32 v25, v252, v23
    v_fma_f32 v25, v251, v24, -v25
    v_fmac_f32 v175, v25, v230
    v_mul_f32 v25, v250, v24
    v_fma_f32 v25, v252, v22, -v25
    v_fmac_f32 v179, v25, v230
    v_mul_f32 v25, v251, v22
    v_fma_f32 v25, v250, v23, -v25
    v_fmac_f32 v183, v25, v230
    v_lshlrev_b32 v22, 16, v94
    v_lshlrev_b32 v23, 16, v96
    v_lshlrev_b32 v24, 16, v98
    v_mul_f32 v25, v22, v253
    v_fmac_f32 v25, v23, v254
    v_fmac_f32 v25, v24, v255
    v_fmac_f32 v144, v25, v187
    v_fmac_f32 v160, v22, v203
    v_fmac_f32 v164, v23, v203
    v_fmac_f32 v168, v24, v203
    v_mul_f32 v25, v255, v23
    v_fma_f32 v25, v254, v24, -v25
    v_fmac_f32 v172, v25, v219
    v_mul_f32 v25, v253, v24
    v_fma_f32 v25, v255, v22, -v25
    v_fmac_f32 v176, v25, v219
    v_mul_f32 v25, v254, v22
    v_fma_f32 v25, v253, v23, -v25
    v_fmac_f32 v180, v25, v219
    v_and_b32 v22, 0xffff0000, v94
    v_and_b32 v23, 0xffff0000, v96
    v_and_b32 v24, 0xffff0000, v98
    v_mul_f32 v25, v22, v253
    v_fmac_f32 v25, v23, v254
    v_fmac_f32 v25, v24, v255
    v_fmac_f32 v145, v25, v191
    v_fmac_f32 v161, v22, v207
    v_fmac_f32 v165, v23, v207
    v_fmac_f32 v169, v24, v207
    v_mul_f32 v25, v255, v23
    v_fma_f32 v25, v254, v24, -v25
    v_fmac_f32 v173, v25, v223
    v_mul_f32 v25, v253, v24
    v_fma_f32 v25, v255, v22, -v25
    v_fmac_f32 v177, v25, v223
    v_mul_f32 v25, v254, v22
    v_fma_f32 v25, v253, v23, -v25
    v_fmac_f32 v181, v25, v223
    v_lshlrev_b32 v22, 16, v95
    v_lshlrev_b32 v23, 16, v97
    v_lshlrev_b32 v24, 16, v99
    v_mul_f32 v25, v22, v253
    v_fmac_f32 v25, v23, v254
    v_fmac_f32 v25, v24, v255
    v_fmac_f32 v146, v25, v195
    v_fmac_f32 v162, v22, v211
    v_fmac_f32 v166, v23, v211
    v_fmac_f32 v170, v24, v211
    v_mul_f32 v25, v255, v23
    v_fma_f32 v25, v254, v24, -v25
    v_fmac_f32 v174, v25, v227
    v_mul_f32 v25, v253, v24
    v_fma_f32 v25, v255, v22, -v25
    v_fmac_f32 v178, v25, v227
    v_mul_f32 v25, v254, v22
    v_fma_f32 v25, v253, v23, -v25
    v_fmac_f32 v182, v25, v227
    v_and_b32 v22, 0xffff0000, v95
    v_and_b32 v23, 0xffff0000, v97
    v_and_b32 v24, 0xffff0000, v99
    v_mul_f32 v25, v22, v253
    v_fmac_f32 v25, v23, v254
    v_fmac_f32 v25, v24, v255
    v_fmac_f32 v147, v25, v199
    v_fmac_f32 v163, v22, v215
    v_fmac_f32 v167, v23, v215
    v_fmac_f32 v171, v24, v215
    v_mul_f32 v25, v255, v23
    v_fma_f32 v25, v254, v24, -v25
    v_fmac_f32 v175, v25, v231
    v_mul_f32 v25, v253, v24
    v_fma_f32 v25, v255, v22, -v25
    v_fmac_f32 v179, v25, v231
    v_mul_f32 v25, v254, v22
    v_fma_f32 v25, v253, v23, -v25
    v_fmac_f32 v183, v25, v231
    v_add_u32 v32, 4, v32
    v_add_u32 v33, 4, v33
    s_branch L_m_loop
L_m_next:
    s_waitcnt vmcnt(0)
    s_add_u32 s44, s44, 64
    s_branch L_m_chunk
L_m_done:
    v_lshl_add_u32 v17, v2, 2, v4
    v_mul_u32_u24 v17, 1424, v17
    v_add_u32 v17, v17, v16
    v_cvt_pk_bf16_f32 v22, v140, v141
    v_cvt_pk_bf16_f32 v23, v142, v143
    ds_write_b64 v17, v[22:23] offset:0
    v_cvt_pk_bf16_f32 v22, v144, v145
    v_cvt_pk_bf16_f32 v23, v146, v147
    ds_write_b64 v17, v[22:23] offset:128
    v_cvt_pk_bf16_f32 v22, v148, v149
    v_cvt_pk_bf16_f32 v23, v150, v151
    ds_write_b64 v17, v[22:23] offset:256
    v_cvt_pk_bf16_f32 v22, v152, v153
    v_cvt_pk_bf16_f32 v23, v154, v155
    ds_write_b64 v17, v[22:23] offset:640
    v_cvt_pk_bf16_f32 v22, v156, v157
    v_cvt_pk_bf16_f32 v23, v158, v159
    ds_write_b64 v17, v[22:23] offset:1024
    v_cvt_pk_bf16_f32 v22, v160, v161
    v_cvt_pk_bf16_f32 v23, v162, v163
    ds_write_b64 v17, v[22:23] offset:384
    v_cvt_pk_bf16_f32 v22, v164, v165
    v_cvt_pk_bf16_f32 v23, v166, v167
    ds_write_b64 v17, v[22:23] offset:768
    v_cvt_pk_bf16_f32 v22, v168, v169
    v_cvt_pk_bf16_f32 v23, v170, v171
    ds_write_b64 v17, v[22:23] offset:1152
    v_cvt_pk_bf16_f32 v22, v172, v173
    v_cvt_pk_bf16_f32 v23, v174, v175
    ds_write_b64 v17, v[22:23] offset:512
    v_cvt_pk_bf16_f32 v22, v176, v177
    v_cvt_pk_bf16_f32 v23, v178, v179
    ds_write_b64 v17, v[22:23] offset:896
    v_cvt_pk_bf16_f32 v22, v180, v181
    v_cvt_pk_bf16_f32 v23, v182, v183
    ds_write_b64 v17, v[22:23] offset:1280
    s_waitcnt lgkmcnt(0)
    s_barrier
    v_mul_u32_u24 v17, 1424, v3
    v_lshl_add_u32 v17, v4, 4, v17
    v_lshlrev_b32 v18, 4, v1
    v_lshl_add_u32 v19, v2, 12, v18
    v_mul_u32_u24 v24, 6144, v2
    v_add_u32 v24, v24, v18
    s_mov_b32 s16, 2762752
    s_mov_b32 s17, 2779136
    buffer_load_dwordx4 v[40:43], v19, s[12:15], s16 offen offset:0
    buffer_load_dwordx4 v[44:47], v19, s[12:15], s16 offen offset:1024
    buffer_load_dwordx4 v[48:51], v19, s[12:15], s16 offen offset:2048
    buffer_load_dwordx4 v[52:55], v19, s[12:15], s16 offen offset:3072
    buffer_load_dwordx4 v[56:59], v24, s[12:15], s17 offen offset:0
    buffer_load_dwordx4 v[60:63], v24, s[12:15], s17 offen offset:1024
    buffer_load_dwordx4 v[64:67], v24, s[12:15], s17 offen offset:2048
    buffer_load_dwordx4 v[68:71], v24, s[12:15], s17 offen offset:3072
    s_mov_b32 s17, 2783232
    buffer_load_dwordx4 v[72:75], v24, s[12:15], s17 offen offset:0
    buffer_load_dwordx4 v[76:79], v24, s[12:15], s17 offen offset:1024
    ds_read_b128 v[100:103], v17 offset:0
    ds_read_b128 v[104:107], v17 offset:64
    ds_read_b128 v[108:111], v17 offset:128
    ds_read_b128 v[112:115], v17 offset:192
    ds_read_b128 v[116:119], v17 offset:256
    ds_read_b128 v[120:123], v17 offset:320
    ds_read_b128 v[124:127], v17 offset:384
    ds_read_b128 v[128:131], v17 offset:448
    ds_read_b128 v[132:135], v17 offset:512
    ds_read_b128 v[136:139], v17 offset:576
    ds_read_b128 v[140:143], v17 offset:640
    ds_read_b128 v[144:147], v17 offset:704
    ds_read_b128 v[148:151], v17 offset:768
    ds_read_b128 v[152:155], v17 offset:832
    ds_read_b128 v[156:159], v17 offset:896
    ds_read_b128 v[160:163], v17 offset:960
    ds_read_b128 v[164:167], v17 offset:1024
    ds_read_b128 v[168:171], v17 offset:1088
    ds_read_b128 v[172:175], v17 offset:1152
    ds_read_b128 v[176:179], v17 offset:1216
    ds_read_b128 v[180:183], v17 offset:1280
    ds_read_b128 v[184:187], v17 offset:1344
    s_waitcnt vmcnt(0) lgkmcnt(0)
    v_mfma_f32_16x16x32_bf16 v[200:203], v[40:43], v[100:103], 0
    v_mfma_f32_16x16x32_bf16 v[200:203], v[44:47], v[104:107], v[200:203]
    v_mfma_f32_16x16x32_bf16 v[200:203], v[48:51], v[108:111], v[200:203]
    v_mfma_f32_16x16x32_bf16 v[200:203], v[52:55], v[112:115], v[200:203]
    v_mfma_f32_16x16x32_bf16 v[204:207], v[56:59], v[116:119], 0
    v_mfma_f32_16x16x32_bf16 v[204:207], v[60:63], v[120:123], v[204:207]
    v_mfma_f32_16x16x32_bf16 v[204:207], v[64:67], v[124:127], v[204:207]
    v_mfma_f32_16x16x32_bf16 v[204:207], v[68:71], v[128:131], v[204:207]
    v_mfma_f32_16x16x32_bf16 v[204:207], v[72:75], v[132:135], v[204:207]
    v_mfma_f32_16x16x32_bf16 v[204:207], v[76:79], v[136:139], v[204:207]
    v_mfma_f32_16x16x32_bf16 v[208:211], v[56:59], v[140:143], 0
    v_mfma_f32_16x16x32_bf16 v[208:211], v[60:63], v[144:147], v[208:211]
    v_mfma_f32_16x16x32_bf16 v[208:211], v[64:67], v[148:151], v[208:211]
    v_mfma_f32_16x16x32_bf16 v[208:211], v[68:71], v[152:155], v[208:211]
    v_mfma_f32_16x16x32_bf16 v[208:211], v[72:75], v[156:159], v[208:211]
    v_mfma_f32_16x16x32_bf16 v[208:211], v[76:79], v[160:163], v[208:211]
    v_mfma_f32_16x16x32_bf16 v[212:215], v[56:59], v[164:167], 0
    v_mfma_f32_16x16x32_bf16 v[212:215], v[60:63], v[168:171], v[212:215]
    v_mfma_f32_16x16x32_bf16 v[212:215], v[64:67], v[172:175], v[212:215]
    v_mfma_f32_16x16x32_bf16 v[212:215], v[68:71], v[176:179], v[212:215]
    v_mfma_f32_16x16x32_bf16 v[212:215], v[72:75], v[180:183], v[212:215]
    v_mfma_f32_16x16x32_bf16 v[212:215], v[76:79], v[184:187], v[212:215]
    s_nop 7
    s_nop 7
    v_mul_f32 v220, 0xbfb8aa3b, v200
    v_exp_f32 v220, v220
    s_nop 0
    v_add_f32 v220, 1.0, v220
    v_rcp_f32 v220, v220
    s_nop 0
    v_mul_f32 v204, v204, v220
    v_mul_f32 v208, v208, v220
    v_mul_f32 v212, v212, v220
    v_mul_f32 v221, 0xbfb8aa3b, v201
    v_exp_f32 v221, v221
    s_nop 0
    v_add_f32 v221, 1.0, v221
    v_rcp_f32 v221, v221
    s_nop 0
    v_mul_f32 v205, v205, v221
    v_mul_f32 v209, v209, v221
    v_mul_f32 v213, v213, v221
    v_mul_f32 v222, 0xbfb8aa3b, v202
    v_exp_f32 v222, v222
    s_nop 0
    v_add_f32 v222, 1.0, v222
    v_rcp_f32 v222, v222
    s_nop 0
    v_mul_f32 v206, v206, v222
    v_mul_f32 v210, v210, v222
    v_mul_f32 v214, v214, v222
    v_mul_f32 v223, 0xbfb8aa3b, v203
    v_exp_f32 v223, v223
    s_nop 0
    v_add_f32 v223, 1.0, v223
    v_rcp_f32 v223, v223
    s_nop 0
    v_mul_f32 v207, v207, v223
    v_mul_f32 v211, v211, v223
    v_mul_f32 v215, v215, v223
    v_add_u32 v17, s3, v3
    v_lshlrev_b32 v17, 9, v17
    v_lshl_add_u32 v17, v2, 5, v17
    v_lshl_add_u32 v17, v4, 3, v17
    v_cvt_pk_bf16_f32 v22, v200, v201
    v_cvt_pk_bf16_f32 v23, v202, v203
    buffer_store_dwordx2 v[22:23], v17, s[32:35], 0 offen offset:0
    s_nop 1
    v_cvt_pk_bf16_f32 v22, v204, v205
    v_cvt_pk_bf16_f32 v23, v206, v207
    buffer_store_dwordx2 v[22:23], v17, s[32:35], 0 offen offset:128
    s_nop 1
    v_cvt_pk_bf16_f32 v22, v208, v209
    v_cvt_pk_bf16_f32 v23, v210, v211
    buffer_store_dwordx2 v[22:23], v17, s[32:35], 0 offen offset:256
    s_nop 1
    v_cvt_pk_bf16_f32 v22, v212, v213
    v_cvt_pk_bf16_f32 v23, v214, v215
    buffer_store_dwordx2 v[22:23], v17, s[32:35], 0 offen offset:384
    s_nop 1
L_m_end:
    s_endpgm
.section .rodata,"a"
.p2align 6
.amdhsa_kernel hist_kernel
  .amdhsa_next_free_vgpr 32
  .amdhsa_next_free_sgpr 102
  .amdhsa_accum_offset 32
  .amdhsa_group_segment_fixed_size 0
  .amdhsa_kernarg_size 96
  .amdhsa_user_sgpr_count 2
  .amdhsa_user_sgpr_kernarg_segment_ptr 1
  .amdhsa_system_sgpr_workgroup_id_x 1
.end_amdhsa_kernel
.p2align 6
.amdhsa_kernel scan_kernel
  .amdhsa_next_free_vgpr 80
  .amdhsa_next_free_sgpr 102
  .amdhsa_accum_offset 80
  .amdhsa_group_segment_fixed_size 0
  .amdhsa_kernarg_size 96
  .amdhsa_user_sgpr_count 2
  .amdhsa_user_sgpr_kernarg_segment_ptr 1
  .amdhsa_system_sgpr_workgroup_id_x 1
.end_amdhsa_kernel
.p2align 6
.amdhsa_kernel scatter_kernel
  .amdhsa_next_free_vgpr 128
  .amdhsa_next_free_sgpr 102
  .amdhsa_accum_offset 128
  .amdhsa_group_segment_fixed_size 0
  .amdhsa_kernarg_size 96
  .amdhsa_user_sgpr_count 2
  .amdhsa_user_sgpr_kernarg_segment_ptr 1
  .amdhsa_system_sgpr_workgroup_id_x 1
.end_amdhsa_kernel
.p2align 6
.amdhsa_kernel main_kernel
  .amdhsa_next_free_vgpr 256
  .amdhsa_next_free_sgpr 102
  .amdhsa_accum_offset 256
  .amdhsa_group_segment_fixed_size 0
  .amdhsa_kernarg_size 96
  .amdhsa_user_sgpr_count 2
  .amdhsa_user_sgpr_kernarg_segment_ptr 1
  .amdhsa_system_sgpr_workgroup_id_x 1
.end_amdhsa_kernel
```
